```python
import torch

def _softmax(x, axis=-1):
    return torch.softmax(x, dim=axis)
def _gelu(x):
    return torch.nn.functional.gelu(x, approximate="tanh")
def _silu(x):
    return torch.nn.functional.silu(x)
def _sigmoid(x):
    return torch.sigmoid(x)
def _layernorm(x, axis=-1, eps=1e-5):
    m = x.mean(dim=axis, keepdim=True)
    v = x.var(dim=axis, keepdim=True, unbiased=False)
    return (x - m) / torch.sqrt(v + eps)
def _scatter_add(tgt, idx, src, axis=0):
    return tgt.clone().index_add_(axis, idx, src)
def _segment_sum(src, seg, n):
    out = torch.zeros((n,) + src.shape[1:], dtype=src.dtype)
    return out.index_add_(0, seg, src)
def _pad(x, pw):
    flat = tuple(v for pair in reversed(pw) for v in pair)
    return torch.nn.functional.pad(x, flat)

kernel_name = 'parallel_sum__mha_block__swiglu_ffn__prompt'

def setup_inputs():

    _w = (lambda a: (lambda t: t.to(torch.bfloat16) if t.is_floating_point() else t)(torch.as_tensor(a)))
    def _A_setup():
        B, S, D, H = 1, 2048, 512, 32
        return {
            "x": _w((lambda *s: torch.randn(*s, dtype=torch.bfloat16) * 0.05)(B, S, D)),
            "wqkv": _w((lambda *s: torch.randn(*s, dtype=torch.bfloat16) * 0.2)(D, 3 * D)),
            "wo": _w((lambda *s: torch.randn(*s, dtype=torch.bfloat16) * 0.1)(D, D)),
        }
    _A_in = _A_setup()

    def _B_setup():
        B, S, D, F = 1, 2048, 512, 1792
        return {
            "x": _w((lambda *s: torch.randn(*s, dtype=torch.bfloat16) * 0.05)(B, S, D)),
            "w_gate": _w((lambda *s: torch.randn(*s, dtype=torch.bfloat16) * 0.1)(D, F)),
            "w_up": _w((lambda *s: torch.randn(*s, dtype=torch.bfloat16) * 0.1)(D, F)),
            "w_down": _w((lambda *s: torch.randn(*s, dtype=torch.bfloat16) * 0.1)(F, D)),
        }
    _B_in = _B_setup()

    return {
        "A_x": _A_in["x"],
        "A_wqkv": _A_in["wqkv"],
        "A_wo": _A_in["wo"],
        "B_x": _B_in["x"],
        "B_w_gate": _B_in["w_gate"],
        "B_w_up": _B_in["w_up"],
        "B_w_down": _B_in["w_down"],
    }

def reference(A_x, A_wqkv, A_wo, B_x, B_w_gate, B_w_up, B_w_down):
    def _A_ref(x, wqkv, wo):
        B, S, D = x.shape
        H = 32
        Dh = D // H
        qkv = (lambda x, *d: x.permute(*d))((x @ wqkv).reshape(B, S, 3, H, Dh), 2, 0, 3, 1, 4)
        q, k, v = qkv[0], qkv[1], qkv[2]
        scores = torch.einsum("bhqd,bhkd->bhqk", q, k) * (Dh ** -0.5)
        p = _softmax(scores, axis=-1)
        o = torch.einsum("bhqk,bhkd->bhqd", p, v)
        return (lambda x, *d: x.permute(*d))(o, 0, 2, 1, 3).reshape(B, S, D) @ wo

    def _B_ref(x, w_gate, w_up, w_down):
        g = _silu(x @ w_gate)
        u = x @ w_up
        return (g * u) @ w_down

    x = A_x
    xn = _layernorm(x, axis=-1)
    return x + _A_ref(xn, A_wqkv, A_wo) + _B_ref(xn, B_w_gate, B_w_up, B_w_down)
```

```asm
; @launch grid=(512,1,1) block=(256,1,1) lds=81920
.amdgcn_target "amdgcn-amd-amdhsa--gfx950"
.text
.globl parallel_sum__mha_block__swiglu_ffn__prompt_kernel
.p2align 8
.type parallel_sum__mha_block__swiglu_ffn__prompt_kernel,@function
parallel_sum__mha_block__swiglu_ffn__prompt_kernel:
    s_cmp_ge_u32 s2, 512
    s_cbranch_scc1 parallel_sum__mha_block__swiglu_ffn__prompt_kernel_done
    s_load_dwordx16 s[16:31], s[0:1], 0
    s_load_dwordx4 s[32:35], s[0:1], 64
    s_memrealtime s[10:11]
    v_and_b32 v1, 63, v0
    v_lshrrev_b32 v2, 6, v0
    s_and_b32 s3, s2, 7
    v_readfirstlane_b32 s40, v2
    s_bfe_u32 s4, s2, 0x50003
    s_and_b32 s5, s3, 1
    s_lshl_b32 s5, s5, 3
    s_and_b32 s6, s4, 7
    s_add_u32 s41, s5, s6
    s_lshr_b32 s5, s3, 1
    s_lshl_b32 s5, s5, 2
    s_lshr_b32 s6, s4, 3
    s_add_u32 s42, s5, s6
    s_waitcnt lgkmcnt(0)
    s_mov_b32 s36, s34
    s_mov_b32 s37, s35
    s_mov_b32 s38, 33554432
    s_mov_b32 s39, 0x00020000
    s_mov_b32 s56, s32
    s_mov_b32 s57, s33
    s_mov_b32 s58, 256
    s_mov_b32 s59, 0x00020000
    s_cmp_ge_u32 s2, 256
    s_cbranch_scc1 parallel_sum__mha_block__swiglu_ffn__prompt_kernel_B
    s_setprio 2
    s_or_b32 s3, s2, s40
    s_cmp_lg_u32 s3, 0
    s_cbranch_scc1 parallel_sum__mha_block__swiglu_ffn__prompt_kernel_A
    s_or_b32 s10, s10, 1
    v_mov_b32 v2, s10
    v_mov_b32 v3, 0
    s_mov_b64 exec, 1
    buffer_store_dword v2, v3, s[56:59], 0 offen sc1
    s_mov_b64 exec, -1
    s_waitcnt vmcnt(0)
parallel_sum__mha_block__swiglu_ffn__prompt_kernel_A:
    s_mov_b32 s48, s18
    s_mov_b32 s49, s19
    s_mov_b32 s50, 1572864
    s_mov_b32 s51, 0x00020000
    s_and_b32 s3, s40, 1
    s_lshr_b32 s4, s40, 1
    v_lshrrev_b32 v16, 2, v1
    v_and_b32 v17, 3, v1
    v_mul_u32_u24 v6, 3072, v16
    v_lshl_add_u32 v6, v17, 4, v6
    s_lshl_b32 s64, s42, 6
    s_mul_i32 s5, s3, 49152
    s_add_u32 s64, s64, s5
    v_add_u32 v7, 2048, v6
    s_lshl_b32 s5, s4, 10
    v_add_u32 v6, s5, v6
    s_lshl_b32 s6, s3, 10
    s_add_u32 s69, s6, 34816
    s_lshl_b32 s5, s4, 15
    s_add_u32 s68, s5, s6
    s_cmp_eq_u32 s4, 0
    s_cselect_b32 s14, -1, 0
    s_cselect_b32 s15, 0, -1
    s_cselect_b32 s66, 0, 49152
    s_movk_i32 s65, 2048
    s_lshl_b32 s65, s65, s4
    s_and_b32 s10, s41, 7
    s_and_b32 s11, s42, 3
    s_lshl_b32 s11, s11, 1
    s_add_u32 s10, s10, s11
    s_add_u32 s10, s10, 1
    s_and_b32 s74, s10, 7
    s_mul_i32 s11, s74, 196608
    s_add_u32 s64, s64, s11
    s_sub_u32 s67, 8, s74
    v_lshrrev_b32 v17, 5, v1
    v_bfe_u32 v18, v1, 2, 2
    v_lshl_add_u32 v18, v17, 3, v18
    v_and_b32 v19, 3, v1
    v_bfe_u32 v20, v1, 4, 1
    v_lshlrev_b32 v8, 6, v18
    v_lshl_add_u32 v8, v20, 5, v8
    v_lshl_add_u32 v8, v19, 3, v8
    v_add_u32 v9, 32768, v8
    v_mov_b32 v64, 0
    v_mov_b32 v65, 0
    v_mov_b32 v66, 0
    v_mov_b32 v67, 0
    v_mov_b32 v68, 0
    v_mov_b32 v69, 0
    v_mov_b32 v70, 0
    v_mov_b32 v71, 0
    v_mov_b32 v72, 0
    v_mov_b32 v73, 0
    v_mov_b32 v74, 0
    v_mov_b32 v75, 0
    v_mov_b32 v76, 0
    v_mov_b32 v77, 0
    v_mov_b32 v78, 0
    v_mov_b32 v79, 0
    v_mov_b32 v80, 0
    v_mov_b32 v81, 0
    v_mov_b32 v82, 0
    v_mov_b32 v83, 0
    v_mov_b32 v84, 0
    v_mov_b32 v85, 0
    v_mov_b32 v86, 0
    v_mov_b32 v87, 0
    v_mov_b32 v88, 0
    v_mov_b32 v89, 0
    v_mov_b32 v90, 0
    v_mov_b32 v91, 0
    v_mov_b32 v92, 0
    v_mov_b32 v93, 0
    v_mov_b32 v94, 0
    v_mov_b32 v95, 0
    v_mov_b32 v96, 0
    v_mov_b32 v97, 0
    v_mov_b32 v98, 0
    v_mov_b32 v99, 0
    v_mov_b32 v100, 0
    v_mov_b32 v101, 0
    v_mov_b32 v102, 0
    v_mov_b32 v103, 0
    v_mov_b32 v104, 0
    v_mov_b32 v105, 0
    v_mov_b32 v106, 0
    v_mov_b32 v107, 0
    v_mov_b32 v108, 0
    v_mov_b32 v109, 0
    v_mov_b32 v110, 0
    v_mov_b32 v111, 0
    v_lshlrev_b32 v2, 4, v1
    v_mov_b32 v241, 0
    buffer_load_dword v240, v241, s[56:59], 0 offen sc1
    s_waitcnt vmcnt(0)
    s_mov_b32 m0, s68
    s_add_u32 s68, s68, s65
    buffer_load_dwordx4 v6, s[48:51], s64 offen lds
    s_add_u32 m0, s69, 0
    s_mov_b64 exec, s[14:15]
    buffer_load_dwordx4 v7, s[48:51], s64 offen lds
    s_mov_b64 exec, -1
    s_add_u32 s64, s64, 98304
    s_mov_b32 m0, s68
    s_add_u32 s68, s68, s65
    buffer_load_dwordx4 v6, s[48:51], s64 offen lds
    s_add_u32 m0, s69, 4096
    s_mov_b64 exec, s[14:15]
    buffer_load_dwordx4 v7, s[48:51], s64 offen lds
    s_mov_b64 exec, -1
    s_add_u32 s64, s64, 98304
    s_sub_u32 s67, s67, 1
    s_cmp_eq_u32 s67, 0
    s_cselect_b32 s10, 1572864, 0
    s_sub_u32 s64, s64, s10
    s_mov_b32 m0, s68
    s_add_u32 s68, s68, s65
    buffer_load_dwordx4 v6, s[48:51], s64 offen lds
    s_add_u32 m0, s69, 8192
    s_mov_b64 exec, s[14:15]
    buffer_load_dwordx4 v7, s[48:51], s64 offen lds
    s_mov_b64 exec, -1
    s_add_u32 s64, s64, 98304
    s_mov_b32 m0, s68
    s_add_u32 s68, s68, s65
    buffer_load_dwordx4 v6, s[48:51], s64 offen lds
    s_add_u32 m0, s69, 12288
    s_mov_b64 exec, s[14:15]
    buffer_load_dwordx4 v7, s[48:51], s64 offen lds
    s_mov_b64 exec, -1
    s_add_u32 s64, s64, 98304
    s_sub_u32 s67, s67, 1
    s_cmp_eq_u32 s67, 0
    s_cselect_b32 s10, 1572864, 0
    s_sub_u32 s64, s64, s10
    s_mov_b32 m0, s68
    s_add_u32 s68, s68, s65
    buffer_load_dwordx4 v6, s[48:51], s64 offen lds
    s_add_u32 m0, s69, 16384
    s_mov_b64 exec, s[14:15]
    buffer_load_dwordx4 v7, s[48:51], s64 offen lds
    s_mov_b64 exec, -1
    s_add_u32 s64, s64, 98304
    s_mov_b32 m0, s68
    s_add_u32 s68, s68, s65
    buffer_load_dwordx4 v6, s[48:51], s64 offen lds
    s_add_u32 m0, s69, 20480
    s_mov_b64 exec, s[14:15]
    buffer_load_dwordx4 v7, s[48:51], s64 offen lds
    s_mov_b64 exec, -1
    s_add_u32 s64, s64, 98304
    s_sub_u32 s67, s67, 1
    s_cmp_eq_u32 s67, 0
    s_cselect_b32 s10, 1572864, 0
    s_sub_u32 s64, s64, s10
    s_mov_b32 m0, s68
    s_add_u32 s68, s68, s65
    buffer_load_dwordx4 v6, s[48:51], s64 offen lds
    s_add_u32 m0, s69, 24576
    s_mov_b64 exec, s[14:15]
    buffer_load_dwordx4 v7, s[48:51], s64 offen lds
    s_mov_b64 exec, -1
    s_add_u32 s64, s64, 98304
    s_mov_b32 m0, s68
    s_add_u32 s68, s68, s65
    buffer_load_dwordx4 v6, s[48:51], s64 offen lds
    s_add_u32 m0, s69, 28672
    s_mov_b64 exec, s[14:15]
    buffer_load_dwordx4 v7, s[48:51], s64 offen lds
    s_mov_b64 exec, -1
    s_add_u32 s64, s64, 98304
    s_sub_u32 s67, s67, 1
    s_cmp_eq_u32 s67, 0
    s_cselect_b32 s10, 1572864, 0
    s_sub_u32 s64, s64, s10
    s_mov_b32 m0, s68
    s_add_u32 s68, s68, s65
    buffer_load_dwordx4 v6, s[48:51], s64 offen lds
    s_add_u32 m0, s69, 32768
    s_mov_b64 exec, s[14:15]
    buffer_load_dwordx4 v7, s[48:51], s64 offen lds
    s_mov_b64 exec, -1
    s_add_u32 s64, s64, 98304
    s_mov_b32 m0, s68
    s_add_u32 s68, s68, s65
    buffer_load_dwordx4 v6, s[48:51], s64 offen lds
    s_add_u32 m0, s69, 36864
    s_mov_b64 exec, s[14:15]
    buffer_load_dwordx4 v7, s[48:51], s64 offen lds
    s_mov_b64 exec, -1
    s_add_u32 s64, s64, 98304
    s_sub_u32 s67, s67, 1
    s_cmp_eq_u32 s67, 0
    s_cselect_b32 s10, 1572864, 0
    s_sub_u32 s64, s64, s10
    s_mov_b32 m0, s68
    s_add_u32 s68, s68, s65
    buffer_load_dwordx4 v6, s[48:51], s64 offen lds
    s_add_u32 m0, s69, 40960
    s_mov_b64 exec, s[14:15]
    buffer_load_dwordx4 v7, s[48:51], s64 offen lds
    s_mov_b64 exec, -1
    s_add_u32 s64, s64, 98304
    s_mov_b32 m0, s68
    s_add_u32 s68, s68, s65
    buffer_load_dwordx4 v6, s[48:51], s64 offen lds
    s_add_u32 m0, s69, 45056
    s_mov_b64 exec, s[14:15]
    buffer_load_dwordx4 v7, s[48:51], s64 offen lds
    s_mov_b64 exec, -1
    s_add_u32 s64, s64, 98304
    s_sub_u32 s67, s67, 1
    s_cmp_eq_u32 s67, 0
    s_cselect_b32 s10, 1572864, 0
    s_sub_u32 s64, s64, s10
    v_readfirstlane_b32 s83, v240
    s_nop 3
    s_cmp_lg_u32 s83, 0
    s_cbranch_scc1 g1A_nonce
    v_mov_b32 v241, 0
    s_mov_b32 s3, 200000
nonce1:
    buffer_load_dword v240, v241, s[56:59], 0 offen sc1
    s_waitcnt vmcnt(0)
    v_readfirstlane_b32 s83, v240
    s_sub_u32 s3, s3, 1
    s_cmp_eq_u32 s3, 0
    s_cbranch_scc1 nonce1_ok
    s_cmp_lg_u32 s83, 0
    s_cbranch_scc1 nonce1_ok
    s_sleep 8
    s_branch nonce1
nonce1_ok:
g1A_nonce:
    s_lshl_b32 s43, s41, 2
    s_add_u32 s43, s43, s40
    s_lshl_b32 s4, s41, 8
    s_add_u32 s4, s4, 20983808
    s_cmp_lg_u32 s40, 0
    s_cbranch_scc1 poll2_ok
    v_and_b32 v241, 63, v1
    v_lshlrev_b32 v241, 2, v241
    s_mov_b32 s3, 200000
poll2:
    buffer_load_dword v240, v241, s[36:39], s4 offen sc1
    s_waitcnt vmcnt(0)
    v_cmp_ne_u32 vcc, s83, v240
    s_cbranch_vccz poll2_ok
    s_sleep 4
    s_sub_u32 s3, s3, 1
    s_cmp_lg_u32 s3, 0
    s_cbranch_scc1 poll2
poll2_ok:
    s_waitcnt vmcnt(0)
    s_barrier
    s_lshl_b32 s70, s43, 15
    s_lshl_b32 s73, s74, 12
    s_add_u32 s72, s70, s73
    buffer_load_dwordx4 v[112:115], v2, s[36:39], s72 offen offset:0 sc1
    buffer_load_dwordx4 v[116:119], v2, s[36:39], s72 offen offset:1024 sc1
    buffer_load_dwordx4 v[120:123], v2, s[36:39], s72 offen offset:2048 sc1
    buffer_load_dwordx4 v[124:127], v2, s[36:39], s72 offen offset:3072 sc1
    s_add_u32 s73, s73, 4096
    s_and_b32 s73, s73, 32767
    s_add_u32 s72, s70, s73
    buffer_load_dwordx4 v[128:131], v2, s[36:39], s72 offen offset:0 sc1
    buffer_load_dwordx4 v[132:135], v2, s[36:39], s72 offen offset:1024 sc1
    buffer_load_dwordx4 v[136:139], v2, s[36:39], s72 offen offset:2048 sc1
    buffer_load_dwordx4 v[140:143], v2, s[36:39], s72 offen offset:3072 sc1
    s_add_u32 s73, s73, 4096
    s_and_b32 s73, s73, 32767
    s_add_u32 s72, s70, s73
    buffer_load_dwordx4 v[144:147], v2, s[36:39], s72 offen offset:0 sc1
    buffer_load_dwordx4 v[148:151], v2, s[36:39], s72 offen offset:1024 sc1
    buffer_load_dwordx4 v[152:155], v2, s[36:39], s72 offen offset:2048 sc1
    buffer_load_dwordx4 v[156:159], v2, s[36:39], s72 offen offset:3072 sc1
    ds_read_b64_tr_b16 v[16:17], v9 offset:0
    ds_read_b64_tr_b16 v[18:19], v9 offset:256
    ds_read_b64_tr_b16 v[20:21], v9 offset:2048
    ds_read_b64_tr_b16 v[22:23], v9 offset:2304
    ds_read_b64_tr_b16 v[24:25], v9 offset:1024
    ds_read_b64_tr_b16 v[26:27], v9 offset:1280
    ds_read_b64_tr_b16 v[28:29], v9 offset:3072
    ds_read_b64_tr_b16 v[30:31], v9 offset:3328
    s_add_u32 s73, s73, 4096
    s_and_b32 s73, s73, 32767
    s_add_u32 s72, s70, s73
    buffer_load_dwordx4 v[160:163], v2, s[36:39], s72 offen offset:0 sc1
    s_waitcnt vmcnt(12)
    s_waitcnt lgkmcnt(4)
    v_mfma_f32_32x32x16_bf16 v[80:95], v[16:19], v[112:115], v[80:95]
    ds_read_b64_tr_b16 v[32:33], v9 offset:4096
    ds_read_b64_tr_b16 v[34:35], v9 offset:4352
    v_mfma_f32_32x32x16_bf16 v[96:111], v[112:115], v[20:23], v[96:111]
    ds_read_b64_tr_b16 v[36:37], v9 offset:6144
    ds_read_b64_tr_b16 v[38:39], v9 offset:6400
    buffer_load_dwordx4 v[164:167], v2, s[36:39], s72 offen offset:1024 sc1
    s_waitcnt vmcnt(12)
    s_waitcnt lgkmcnt(4)
    v_mfma_f32_32x32x16_bf16 v[80:95], v[24:27], v[116:119], v[80:95]
    ds_read_b64_tr_b16 v[40:41], v9 offset:5120
    ds_read_b64_tr_b16 v[42:43], v9 offset:5376
    v_mfma_f32_32x32x16_bf16 v[96:111], v[116:119], v[28:31], v[96:111]
    ds_read_b64_tr_b16 v[44:45], v9 offset:7168
    ds_read_b64_tr_b16 v[46:47], v9 offset:7424
    buffer_load_dwordx4 v[168:171], v2, s[36:39], s72 offen offset:2048 sc1
    s_waitcnt vmcnt(12)
    s_waitcnt lgkmcnt(4)
    v_mfma_f32_32x32x16_bf16 v[80:95], v[32:35], v[120:123], v[80:95]
    ds_read_b64_tr_b16 v[16:17], v9 offset:8192
    ds_read_b64_tr_b16 v[18:19], v9 offset:8448
    v_mfma_f32_32x32x16_bf16 v[96:111], v[120:123], v[36:39], v[96:111]
    ds_read_b64_tr_b16 v[20:21], v9 offset:10240
    ds_read_b64_tr_b16 v[22:23], v9 offset:10496
    buffer_load_dwordx4 v[172:175], v2, s[36:39], s72 offen offset:3072 sc1
    s_waitcnt vmcnt(12)
    s_waitcnt lgkmcnt(4)
    v_mfma_f32_32x32x16_bf16 v[80:95], v[40:43], v[124:127], v[80:95]
    ds_read_b64_tr_b16 v[24:25], v9 offset:9216
    ds_read_b64_tr_b16 v[26:27], v9 offset:9472
    v_mfma_f32_32x32x16_bf16 v[96:111], v[124:127], v[44:47], v[96:111]
    ds_read_b64_tr_b16 v[28:29], v9 offset:11264
    ds_read_b64_tr_b16 v[30:31], v9 offset:11520
    s_add_u32 s73, s73, 4096
    s_and_b32 s73, s73, 32767
    s_add_u32 s72, s70, s73
    buffer_load_dwordx4 v[176:179], v2, s[36:39], s72 offen offset:0 sc1
    s_waitcnt vmcnt(12)
    s_waitcnt lgkmcnt(4)
    v_mfma_f32_32x32x16_bf16 v[80:95], v[16:19], v[128:131], v[80:95]
    ds_read_b64_tr_b16 v[32:33], v9 offset:12288
    ds_read_b64_tr_b16 v[34:35], v9 offset:12544
    v_mfma_f32_32x32x16_bf16 v[96:111], v[128:131], v[20:23], v[96:111]
    ds_read_b64_tr_b16 v[36:37], v9 offset:14336
    ds_read_b64_tr_b16 v[38:39], v9 offset:14592
    buffer_load_dwordx4 v[180:183], v2, s[36:39], s72 offen offset:1024 sc1
    s_waitcnt vmcnt(12)
    s_waitcnt lgkmcnt(4)
    v_mfma_f32_32x32x16_bf16 v[80:95], v[24:27], v[132:135], v[80:95]
    ds_read_b64_tr_b16 v[40:41], v9 offset:13312
    ds_read_b64_tr_b16 v[42:43], v9 offset:13568
    v_mfma_f32_32x32x16_bf16 v[96:111], v[132:135], v[28:31], v[96:111]
    ds_read_b64_tr_b16 v[44:45], v9 offset:15360
    ds_read_b64_tr_b16 v[46:47], v9 offset:15616
    buffer_load_dwordx4 v[184:187], v2, s[36:39], s72 offen offset:2048 sc1
    s_waitcnt vmcnt(12)
    s_waitcnt lgkmcnt(4)
    v_mfma_f32_32x32x16_bf16 v[80:95], v[32:35], v[136:139], v[80:95]
    ds_read_b64_tr_b16 v[16:17], v9 offset:16384
    ds_read_b64_tr_b16 v[18:19], v9 offset:16640
    v_mfma_f32_32x32x16_bf16 v[96:111], v[136:139], v[36:39], v[96:111]
    ds_read_b64_tr_b16 v[20:21], v9 offset:18432
    ds_read_b64_tr_b16 v[22:23], v9 offset:18688
    buffer_load_dwordx4 v[188:191], v2, s[36:39], s72 offen offset:3072 sc1
    s_waitcnt vmcnt(12)
    s_waitcnt lgkmcnt(4)
    v_mfma_f32_32x32x16_bf16 v[80:95], v[40:43], v[140:143], v[80:95]
    ds_read_b64_tr_b16 v[24:25], v9 offset:17408
    ds_read_b64_tr_b16 v[26:27], v9 offset:17664
    v_mfma_f32_32x32x16_bf16 v[96:111], v[140:143], v[44:47], v[96:111]
    ds_read_b64_tr_b16 v[28:29], v9 offset:19456
    ds_read_b64_tr_b16 v[30:31], v9 offset:19712
    s_add_u32 s73, s73, 4096
    s_and_b32 s73, s73, 32767
    s_add_u32 s72, s70, s73
    buffer_load_dwordx4 v[192:195], v2, s[36:39], s72 offen offset:0 sc1
    s_waitcnt vmcnt(12)
    s_waitcnt lgkmcnt(4)
    v_mfma_f32_32x32x16_bf16 v[80:95], v[16:19], v[144:147], v[80:95]
    ds_read_b64_tr_b16 v[32:33], v9 offset:20480
    ds_read_b64_tr_b16 v[34:35], v9 offset:20736
    v_mfma_f32_32x32x16_bf16 v[96:111], v[144:147], v[20:23], v[96:111]
    ds_read_b64_tr_b16 v[36:37], v9 offset:22528
    ds_read_b64_tr_b16 v[38:39], v9 offset:22784
    buffer_load_dwordx4 v[196:199], v2, s[36:39], s72 offen offset:1024 sc1
    s_waitcnt vmcnt(12)
    s_waitcnt lgkmcnt(4)
    v_mfma_f32_32x32x16_bf16 v[80:95], v[24:27], v[148:151], v[80:95]
    ds_read_b64_tr_b16 v[40:41], v9 offset:21504
    ds_read_b64_tr_b16 v[42:43], v9 offset:21760
    v_mfma_f32_32x32x16_bf16 v[96:111], v[148:151], v[28:31], v[96:111]
    ds_read_b64_tr_b16 v[44:45], v9 offset:23552
    ds_read_b64_tr_b16 v[46:47], v9 offset:23808
    s_barrier
    s_sub_u32 s68, s68, s66
    s_mov_b32 m0, s68
    s_add_u32 s68, s68, s65
    buffer_load_dwordx4 v6, s[48:51], s64 offen lds
    s_add_u32 m0, s69, 0
    s_mov_b64 exec, s[14:15]
    buffer_load_dwordx4 v7, s[48:51], s64 offen lds
    s_mov_b64 exec, -1
    s_add_u32 s64, s64, 98304
    s_mov_b32 m0, s68
    s_add_u32 s68, s68, s65
    buffer_load_dwordx4 v6, s[48:51], s64 offen lds
    s_add_u32 m0, s69, 4096
    s_mov_b64 exec, s[14:15]
    buffer_load_dwordx4 v7, s[48:51], s64 offen lds
    s_mov_b64 exec, -1
    s_add_u32 s64, s64, 98304
    s_sub_u32 s67, s67, 1
    s_cmp_eq_u32 s67, 0
    s_cselect_b32 s10, 1572864, 0
    s_sub_u32 s64, s64, s10
    s_mov_b32 m0, s68
    s_add_u32 s68, s68, s65
    buffer_load_dwordx4 v6, s[48:51], s64 offen lds
    s_add_u32 m0, s69, 8192
    s_mov_b64 exec, s[14:15]
    buffer_load_dwordx4 v7, s[48:51], s64 offen lds
    s_mov_b64 exec, -1
    s_add_u32 s64, s64, 98304
    s_mov_b32 m0, s68
    s_add_u32 s68, s68, s65
    buffer_load_dwordx4 v6, s[48:51], s64 offen lds
    s_add_u32 m0, s69, 12288
    s_mov_b64 exec, s[14:15]
    buffer_load_dwordx4 v7, s[48:51], s64 offen lds
    s_mov_b64 exec, -1
    s_add_u32 s64, s64, 98304
    s_sub_u32 s67, s67, 1
    s_cmp_eq_u32 s67, 0
    s_cselect_b32 s10, 1572864, 0
    s_sub_u32 s64, s64, s10
    buffer_load_dwordx4 v[200:203], v2, s[36:39], s72 offen offset:2048 sc1
    s_waitcnt vmcnt(20)
    s_waitcnt lgkmcnt(4)
    v_mfma_f32_32x32x16_bf16 v[80:95], v[32:35], v[152:155], v[80:95]
    ds_read_b64_tr_b16 v[16:17], v9 offset:24576
    ds_read_b64_tr_b16 v[18:19], v9 offset:24832
    v_mfma_f32_32x32x16_bf16 v[96:111], v[152:155], v[36:39], v[96:111]
    ds_read_b64_tr_b16 v[20:21], v9 offset:26624
    ds_read_b64_tr_b16 v[22:23], v9 offset:26880
    buffer_load_dwordx4 v[204:207], v2, s[36:39], s72 offen offset:3072 sc1
    s_waitcnt vmcnt(20)
    s_waitcnt lgkmcnt(4)
    v_mfma_f32_32x32x16_bf16 v[80:95], v[40:43], v[156:159], v[80:95]
    ds_read_b64_tr_b16 v[24:25], v9 offset:25600
    ds_read_b64_tr_b16 v[26:27], v9 offset:25856
    v_mfma_f32_32x32x16_bf16 v[96:111], v[156:159], v[44:47], v[96:111]
    ds_read_b64_tr_b16 v[28:29], v9 offset:27648
    ds_read_b64_tr_b16 v[30:31], v9 offset:27904
    s_add_u32 s73, s73, 4096
    s_and_b32 s73, s73, 32767
    s_add_u32 s72, s70, s73
    buffer_load_dwordx4 v[208:211], v2, s[36:39], s72 offen offset:0 sc1
    s_waitcnt vmcnt(20)
    s_waitcnt lgkmcnt(4)
    v_mfma_f32_32x32x16_bf16 v[80:95], v[16:19], v[160:163], v[80:95]
    ds_read_b64_tr_b16 v[32:33], v9 offset:28672
    ds_read_b64_tr_b16 v[34:35], v9 offset:28928
    v_mfma_f32_32x32x16_bf16 v[96:111], v[160:163], v[20:23], v[96:111]
    ds_read_b64_tr_b16 v[36:37], v9 offset:30720
    ds_read_b64_tr_b16 v[38:39], v9 offset:30976
    buffer_load_dwordx4 v[212:215], v2, s[36:39], s72 offen offset:1024 sc1
    s_waitcnt vmcnt(20)
    s_waitcnt lgkmcnt(4)
    v_mfma_f32_32x32x16_bf16 v[80:95], v[24:27], v[164:167], v[80:95]
    ds_read_b64_tr_b16 v[40:41], v9 offset:29696
    ds_read_b64_tr_b16 v[42:43], v9 offset:29952
    v_mfma_f32_32x32x16_bf16 v[96:111], v[164:167], v[28:31], v[96:111]
    ds_read_b64_tr_b16 v[44:45], v9 offset:31744
    ds_read_b64_tr_b16 v[46:47], v9 offset:32000
    buffer_load_dwordx4 v[216:219], v2, s[36:39], s72 offen offset:2048 sc1
    s_waitcnt vmcnt(20)
    s_waitcnt lgkmcnt(4)
    v_mfma_f32_32x32x16_bf16 v[80:95], v[32:35], v[168:171], v[80:95]
    ds_read_b64_tr_b16 v[16:17], v9 offset:32768
    ds_read_b64_tr_b16 v[18:19], v9 offset:33024
    v_mfma_f32_32x32x16_bf16 v[96:111], v[168:171], v[36:39], v[96:111]
    ds_read_b64_tr_b16 v[20:21], v9 offset:34816
    ds_read_b64_tr_b16 v[22:23], v9 offset:35072
    buffer_load_dwordx4 v[220:223], v2, s[36:39], s72 offen offset:3072 sc1
    s_waitcnt vmcnt(20)
    s_waitcnt lgkmcnt(4)
    v_mfma_f32_32x32x16_bf16 v[80:95], v[40:43], v[172:175], v[80:95]
    ds_read_b64_tr_b16 v[24:25], v9 offset:33792
    ds_read_b64_tr_b16 v[26:27], v9 offset:34048
    v_mfma_f32_32x32x16_bf16 v[96:111], v[172:175], v[44:47], v[96:111]
    ds_read_b64_tr_b16 v[28:29], v9 offset:35840
    ds_read_b64_tr_b16 v[30:31], v9 offset:36096
    s_add_u32 s73, s73, 4096
    s_and_b32 s73, s73, 32767
    s_add_u32 s72, s70, s73
    buffer_load_dwordx4 v[224:227], v2, s[36:39], s72 offen offset:0 sc1
    s_waitcnt vmcnt(20)
    s_waitcnt lgkmcnt(4)
    v_mfma_f32_32x32x16_bf16 v[80:95], v[16:19], v[176:179], v[80:95]
    ds_read_b64_tr_b16 v[32:33], v9 offset:36864
    ds_read_b64_tr_b16 v[34:35], v9 offset:37120
    v_mfma_f32_32x32x16_bf16 v[96:111], v[176:179], v[20:23], v[96:111]
    ds_read_b64_tr_b16 v[36:37], v9 offset:38912
    ds_read_b64_tr_b16 v[38:39], v9 offset:39168
    buffer_load_dwordx4 v[228:231], v2, s[36:39], s72 offen offset:1024 sc1
    s_waitcnt vmcnt(20)
    s_waitcnt lgkmcnt(4)
    v_mfma_f32_32x32x16_bf16 v[80:95], v[24:27], v[180:183], v[80:95]
    ds_read_b64_tr_b16 v[40:41], v9 offset:37888
    ds_read_b64_tr_b16 v[42:43], v9 offset:38144
    v_mfma_f32_32x32x16_bf16 v[96:111], v[180:183], v[28:31], v[96:111]
    ds_read_b64_tr_b16 v[44:45], v9 offset:39936
    ds_read_b64_tr_b16 v[46:47], v9 offset:40192
    buffer_load_dwordx4 v[232:235], v2, s[36:39], s72 offen offset:2048 sc1
    s_waitcnt vmcnt(20)
    s_waitcnt lgkmcnt(4)
    v_mfma_f32_32x32x16_bf16 v[80:95], v[32:35], v[184:187], v[80:95]
    ds_read_b64_tr_b16 v[16:17], v9 offset:40960
    ds_read_b64_tr_b16 v[18:19], v9 offset:41216
    v_mfma_f32_32x32x16_bf16 v[96:111], v[184:187], v[36:39], v[96:111]
    ds_read_b64_tr_b16 v[20:21], v9 offset:43008
    ds_read_b64_tr_b16 v[22:23], v9 offset:43264
    buffer_load_dwordx4 v[236:239], v2, s[36:39], s72 offen offset:3072 sc1
    s_waitcnt vmcnt(20)
    s_waitcnt lgkmcnt(4)
    v_mfma_f32_32x32x16_bf16 v[80:95], v[40:43], v[188:191], v[80:95]
    ds_read_b64_tr_b16 v[24:25], v9 offset:41984
    ds_read_b64_tr_b16 v[26:27], v9 offset:42240
    v_mfma_f32_32x32x16_bf16 v[96:111], v[188:191], v[44:47], v[96:111]
    ds_read_b64_tr_b16 v[28:29], v9 offset:44032
    ds_read_b64_tr_b16 v[30:31], v9 offset:44288
    s_waitcnt vmcnt(19)
    s_waitcnt lgkmcnt(4)
    v_mfma_f32_32x32x16_bf16 v[80:95], v[16:19], v[192:195], v[80:95]
    ds_read_b64_tr_b16 v[32:33], v9 offset:45056
    ds_read_b64_tr_b16 v[34:35], v9 offset:45312
    v_mfma_f32_32x32x16_bf16 v[96:111], v[192:195], v[20:23], v[96:111]
    ds_read_b64_tr_b16 v[36:37], v9 offset:47104
    ds_read_b64_tr_b16 v[38:39], v9 offset:47360
    s_waitcnt vmcnt(18)
    s_waitcnt lgkmcnt(4)
    v_mfma_f32_32x32x16_bf16 v[80:95], v[24:27], v[196:199], v[80:95]
    ds_read_b64_tr_b16 v[40:41], v9 offset:46080
    ds_read_b64_tr_b16 v[42:43], v9 offset:46336
    v_mfma_f32_32x32x16_bf16 v[96:111], v[196:199], v[28:31], v[96:111]
    ds_read_b64_tr_b16 v[44:45], v9 offset:48128
    ds_read_b64_tr_b16 v[46:47], v9 offset:48384
    s_waitcnt vmcnt(9)
    s_barrier
    s_waitcnt lgkmcnt(4)
    v_mfma_f32_32x32x16_bf16 v[80:95], v[32:35], v[200:203], v[80:95]
    ds_read_b64_tr_b16 v[16:17], v9 offset:0
    ds_read_b64_tr_b16 v[18:19], v9 offset:256
    v_mfma_f32_32x32x16_bf16 v[96:111], v[200:203], v[36:39], v[96:111]
    ds_read_b64_tr_b16 v[20:21], v9 offset:2048
    ds_read_b64_tr_b16 v[22:23], v9 offset:2304
    s_waitcnt vmcnt(8)
    s_waitcnt lgkmcnt(4)
    v_mfma_f32_32x32x16_bf16 v[80:95], v[40:43], v[204:207], v[80:95]
    ds_read_b64_tr_b16 v[24:25], v9 offset:1024
    ds_read_b64_tr_b16 v[26:27], v9 offset:1280
    v_mfma_f32_32x32x16_bf16 v[96:111], v[204:207], v[44:47], v[96:111]
    ds_read_b64_tr_b16 v[28:29], v9 offset:3072
    ds_read_b64_tr_b16 v[30:31], v9 offset:3328
    s_waitcnt vmcnt(7)
    s_waitcnt lgkmcnt(4)
    v_mfma_f32_32x32x16_bf16 v[80:95], v[16:19], v[208:211], v[80:95]
    ds_read_b64_tr_b16 v[32:33], v9 offset:4096
    ds_read_b64_tr_b16 v[34:35], v9 offset:4352
    v_mfma_f32_32x32x16_bf16 v[96:111], v[208:211], v[20:23], v[96:111]
    ds_read_b64_tr_b16 v[36:37], v9 offset:6144
    ds_read_b64_tr_b16 v[38:39], v9 offset:6400
    s_waitcnt vmcnt(6)
    s_waitcnt lgkmcnt(4)
    v_mfma_f32_32x32x16_bf16 v[80:95], v[24:27], v[212:215], v[80:95]
    ds_read_b64_tr_b16 v[40:41], v9 offset:5120
    ds_read_b64_tr_b16 v[42:43], v9 offset:5376
    v_mfma_f32_32x32x16_bf16 v[96:111], v[212:215], v[28:31], v[96:111]
    ds_read_b64_tr_b16 v[44:45], v9 offset:7168
    ds_read_b64_tr_b16 v[46:47], v9 offset:7424
    s_waitcnt vmcnt(5)
    s_waitcnt lgkmcnt(4)
    v_mfma_f32_32x32x16_bf16 v[80:95], v[32:35], v[216:219], v[80:95]
    ds_read_b64_tr_b16 v[16:17], v9 offset:8192
    ds_read_b64_tr_b16 v[18:19], v9 offset:8448
    v_mfma_f32_32x32x16_bf16 v[96:111], v[216:219], v[36:39], v[96:111]
    ds_read_b64_tr_b16 v[20:21], v9 offset:10240
    ds_read_b64_tr_b16 v[22:23], v9 offset:10496
    s_waitcnt vmcnt(4)
    s_waitcnt lgkmcnt(4)
    v_mfma_f32_32x32x16_bf16 v[80:95], v[40:43], v[220:223], v[80:95]
    ds_read_b64_tr_b16 v[24:25], v9 offset:9216
    ds_read_b64_tr_b16 v[26:27], v9 offset:9472
    v_mfma_f32_32x32x16_bf16 v[96:111], v[220:223], v[44:47], v[96:111]
    ds_read_b64_tr_b16 v[28:29], v9 offset:11264
    ds_read_b64_tr_b16 v[30:31], v9 offset:11520
    s_waitcnt vmcnt(3)
    s_waitcnt lgkmcnt(4)
    v_mfma_f32_32x32x16_bf16 v[80:95], v[16:19], v[224:227], v[80:95]
    ds_read_b64_tr_b16 v[32:33], v9 offset:12288
    ds_read_b64_tr_b16 v[34:35], v9 offset:12544
    v_mfma_f32_32x32x16_bf16 v[96:111], v[224:227], v[20:23], v[96:111]
    ds_read_b64_tr_b16 v[36:37], v9 offset:14336
    ds_read_b64_tr_b16 v[38:39], v9 offset:14592
    s_waitcnt vmcnt(2)
    s_waitcnt lgkmcnt(4)
    v_mfma_f32_32x32x16_bf16 v[80:95], v[24:27], v[228:231], v[80:95]
    ds_read_b64_tr_b16 v[40:41], v9 offset:13312
    ds_read_b64_tr_b16 v[42:43], v9 offset:13568
    v_mfma_f32_32x32x16_bf16 v[96:111], v[228:231], v[28:31], v[96:111]
    ds_read_b64_tr_b16 v[44:45], v9 offset:15360
    ds_read_b64_tr_b16 v[46:47], v9 offset:15616
    s_waitcnt vmcnt(1)
    s_waitcnt lgkmcnt(4)
    v_mfma_f32_32x32x16_bf16 v[80:95], v[32:35], v[232:235], v[80:95]
    v_mfma_f32_32x32x16_bf16 v[96:111], v[232:235], v[36:39], v[96:111]
    s_waitcnt vmcnt(0)
    s_waitcnt lgkmcnt(0)
    v_mfma_f32_32x32x16_bf16 v[80:95], v[40:43], v[236:239], v[80:95]
    v_mfma_f32_32x32x16_bf16 v[96:111], v[236:239], v[44:47], v[96:111]
    ds_read_b64_tr_b16 v[48:49], v8 offset:0
    ds_read_b64_tr_b16 v[50:51], v8 offset:256
    ds_read_b64_tr_b16 v[52:53], v8 offset:1024
    ds_read_b64_tr_b16 v[54:55], v8 offset:1280
    ds_read_b64_tr_b16 v[56:57], v8 offset:2048
    ds_read_b64_tr_b16 v[58:59], v8 offset:2304
    v_lshrrev_b32 v11, 5, v1
    v_lshlrev_b32 v12, 4, v1
    v_bfe_u32 v13, v1, 4, 1
    v_lshlrev_b32 v13, 16, v13
    v_lshl_add_u32 v13, v11, 8, v13
    v_and_b32 v14, 15, v1
    v_lshl_add_u32 v13, v14, 4, v13
    s_lshl_b32 s3, s42, 17
    s_lshl_b32 s4, s43, 10
    s_add_u32 s3, s3, s4
    s_add_u32 s6, s3, 4194304
    s_add_u32 s7, s3, 4259840
    s_add_u32 s8, s3, 6291456
    v_cvt_pk_bf16_f32 v24, v80, v81
    v_cvt_pk_bf16_f32 v25, v82, v83
    v_cvt_pk_bf16_f32 v26, v84, v85
    v_cvt_pk_bf16_f32 v27, v86, v87
    v_cvt_pk_bf16_f32 v28, v88, v89
    v_cvt_pk_bf16_f32 v29, v90, v91
    v_cvt_pk_bf16_f32 v30, v92, v93
    v_cvt_pk_bf16_f32 v31, v94, v95
    buffer_store_dwordx4 v[24:27], v12, s[36:39], s6 offen sc1
    buffer_store_dwordx4 v[28:31], v12, s[36:39], s7 offen sc1
    v_cvt_pk_bf16_f32 v32, v96, v97
    v_cvt_pk_bf16_f32 v33, v98, v99
    v_cvt_pk_bf16_f32 v34, v100, v101
    v_cvt_pk_bf16_f32 v35, v102, v103
    v_cvt_pk_bf16_f32 v36, v104, v105
    v_cvt_pk_bf16_f32 v37, v106, v107
    v_cvt_pk_bf16_f32 v38, v108, v109
    v_cvt_pk_bf16_f32 v39, v110, v111
    buffer_store_dwordx4 v[32:35], v13, s[36:39], s8 offen sc1
    buffer_store_dwordx4 v[36:39], v13, s[36:39], s8 offen offset:512 sc1
    s_lshl_b32 s4, s42, 8
    s_lshl_b32 s5, s43, 2
    s_add_u32 s4, s4, s5
    s_add_u32 s4, s4, 20971520
    s_mov_b32 s9, 0x3eb8aa3b
    ds_read_b64_tr_b16 v[60:61], v8 offset:3072
    ds_read_b64_tr_b16 v[62:63], v8 offset:3328
    s_waitcnt lgkmcnt(6)
    v_mfma_f32_32x32x16_bf16 v[64:79], v[48:51], v[112:115], v[64:79]
    ds_read_b64_tr_b16 v[48:49], v8 offset:4096
    ds_read_b64_tr_b16 v[50:51], v8 offset:4352
    s_waitcnt lgkmcnt(6)
    v_mfma_f32_32x32x16_bf16 v[64:79], v[52:55], v[116:119], v[64:79]
    ds_read_b64_tr_b16 v[52:53], v8 offset:5120
    ds_read_b64_tr_b16 v[54:55], v8 offset:5376
    s_waitcnt lgkmcnt(6)
    v_mfma_f32_32x32x16_bf16 v[64:79], v[56:59], v[120:123], v[64:79]
    ds_read_b64_tr_b16 v[56:57], v8 offset:6144
    ds_read_b64_tr_b16 v[58:59], v8 offset:6400
    s_waitcnt lgkmcnt(6)
    v_mfma_f32_32x32x16_bf16 v[64:79], v[60:63], v[124:127], v[64:79]
    ds_read_b64_tr_b16 v[60:61], v8 offset:7168
    ds_read_b64_tr_b16 v[62:63], v8 offset:7424
    s_waitcnt lgkmcnt(6)
    v_mfma_f32_32x32x16_bf16 v[64:79], v[48:51], v[128:131], v[64:79]
    ds_read_b64_tr_b16 v[48:49], v8 offset:8192
    ds_read_b64_tr_b16 v[50:51], v8 offset:8448
    s_waitcnt lgkmcnt(6)
    v_mfma_f32_32x32x16_bf16 v[64:79], v[52:55], v[132:135], v[64:79]
    ds_read_b64_tr_b16 v[52:53], v8 offset:9216
    ds_read_b64_tr_b16 v[54:55], v8 offset:9472
    s_waitcnt lgkmcnt(6)
    v_mfma_f32_32x32x16_bf16 v[64:79], v[56:59], v[136:139], v[64:79]
    ds_read_b64_tr_b16 v[56:57], v8 offset:10240
    ds_read_b64_tr_b16 v[58:59], v8 offset:10496
    s_waitcnt lgkmcnt(6)
    v_mfma_f32_32x32x16_bf16 v[64:79], v[60:63], v[140:143], v[64:79]
    ds_read_b64_tr_b16 v[60:61], v8 offset:11264
    ds_read_b64_tr_b16 v[62:63], v8 offset:11520
    s_waitcnt lgkmcnt(6)
    v_mfma_f32_32x32x16_bf16 v[64:79], v[48:51], v[144:147], v[64:79]
    ds_read_b64_tr_b16 v[48:49], v8 offset:12288
    ds_read_b64_tr_b16 v[50:51], v8 offset:12544
    s_waitcnt lgkmcnt(6)
    v_mfma_f32_32x32x16_bf16 v[64:79], v[52:55], v[148:151], v[64:79]
    ds_read_b64_tr_b16 v[52:53], v8 offset:13312
    ds_read_b64_tr_b16 v[54:55], v8 offset:13568
    s_waitcnt lgkmcnt(6)
    v_mfma_f32_32x32x16_bf16 v[64:79], v[56:59], v[152:155], v[64:79]
    ds_read_b64_tr_b16 v[56:57], v8 offset:14336
    ds_read_b64_tr_b16 v[58:59], v8 offset:14592
    s_waitcnt lgkmcnt(6)
    v_mfma_f32_32x32x16_bf16 v[64:79], v[60:63], v[156:159], v[64:79]
    ds_read_b64_tr_b16 v[60:61], v8 offset:15360
    ds_read_b64_tr_b16 v[62:63], v8 offset:15616
    s_waitcnt lgkmcnt(6)
    v_mfma_f32_32x32x16_bf16 v[64:79], v[48:51], v[160:163], v[64:79]
    ds_read_b64_tr_b16 v[48:49], v8 offset:16384
    ds_read_b64_tr_b16 v[50:51], v8 offset:16640
    s_waitcnt lgkmcnt(6)
    v_mfma_f32_32x32x16_bf16 v[64:79], v[52:55], v[164:167], v[64:79]
    v_mov_b32 v240, s83
    v_mov_b32 v241, 0
    s_waitcnt vmcnt(0)
    s_mov_b64 exec, 1
    buffer_store_dword v240, v241, s[36:39], s4 offen sc1
    s_mov_b64 exec, -1
    ds_read_b64_tr_b16 v[52:53], v8 offset:17408
    ds_read_b64_tr_b16 v[54:55], v8 offset:17664
    s_waitcnt lgkmcnt(6)
    v_mfma_f32_32x32x16_bf16 v[64:79], v[56:59], v[168:171], v[64:79]
    ds_read_b64_tr_b16 v[56:57], v8 offset:18432
    ds_read_b64_tr_b16 v[58:59], v8 offset:18688
    s_waitcnt lgkmcnt(6)
    v_mfma_f32_32x32x16_bf16 v[64:79], v[60:63], v[172:175], v[64:79]
    ds_read_b64_tr_b16 v[60:61], v8 offset:19456
    ds_read_b64_tr_b16 v[62:63], v8 offset:19712
    s_waitcnt lgkmcnt(6)
    v_mfma_f32_32x32x16_bf16 v[64:79], v[48:51], v[176:179], v[64:79]
    ds_read_b64_tr_b16 v[48:49], v8 offset:20480
    ds_read_b64_tr_b16 v[50:51], v8 offset:20736
    s_waitcnt lgkmcnt(6)
    v_mfma_f32_32x32x16_bf16 v[64:79], v[52:55], v[180:183], v[64:79]
    ds_read_b64_tr_b16 v[52:53], v8 offset:21504
    ds_read_b64_tr_b16 v[54:55], v8 offset:21760
    s_waitcnt lgkmcnt(6)
    v_mfma_f32_32x32x16_bf16 v[64:79], v[56:59], v[184:187], v[64:79]
    ds_read_b64_tr_b16 v[56:57], v8 offset:22528
    ds_read_b64_tr_b16 v[58:59], v8 offset:22784
    s_waitcnt lgkmcnt(6)
    v_mfma_f32_32x32x16_bf16 v[64:79], v[60:63], v[188:191], v[64:79]
    ds_read_b64_tr_b16 v[60:61], v8 offset:23552
    ds_read_b64_tr_b16 v[62:63], v8 offset:23808
    s_waitcnt lgkmcnt(6)
    v_mfma_f32_32x32x16_bf16 v[64:79], v[48:51], v[192:195], v[64:79]
    ds_read_b64_tr_b16 v[48:49], v8 offset:24576
    ds_read_b64_tr_b16 v[50:51], v8 offset:24832
    s_waitcnt lgkmcnt(6)
    v_mfma_f32_32x32x16_bf16 v[64:79], v[52:55], v[196:199], v[64:79]
    ds_read_b64_tr_b16 v[52:53], v8 offset:25600
    ds_read_b64_tr_b16 v[54:55], v8 offset:25856
    s_waitcnt lgkmcnt(6)
    v_mfma_f32_32x32x16_bf16 v[64:79], v[56:59], v[200:203], v[64:79]
    ds_read_b64_tr_b16 v[56:57], v8 offset:26624
    ds_read_b64_tr_b16 v[58:59], v8 offset:26880
    s_waitcnt lgkmcnt(6)
    v_mfma_f32_32x32x16_bf16 v[64:79], v[60:63], v[204:207], v[64:79]
    ds_read_b64_tr_b16 v[60:61], v8 offset:27648
    ds_read_b64_tr_b16 v[62:63], v8 offset:27904
    s_waitcnt lgkmcnt(6)
    v_mfma_f32_32x32x16_bf16 v[64:79], v[48:51], v[208:211], v[64:79]
    ds_read_b64_tr_b16 v[48:49], v8 offset:28672
    ds_read_b64_tr_b16 v[50:51], v8 offset:28928
    s_waitcnt lgkmcnt(6)
    v_mfma_f32_32x32x16_bf16 v[64:79], v[52:55], v[212:215], v[64:79]
    ds_read_b64_tr_b16 v[52:53], v8 offset:29696
    ds_read_b64_tr_b16 v[54:55], v8 offset:29952
    s_waitcnt lgkmcnt(6)
    v_mfma_f32_32x32x16_bf16 v[64:79], v[56:59], v[216:219], v[64:79]
    ds_read_b64_tr_b16 v[56:57], v8 offset:30720
    ds_read_b64_tr_b16 v[58:59], v8 offset:30976
    s_waitcnt lgkmcnt(6)
    v_mfma_f32_32x32x16_bf16 v[64:79], v[60:63], v[220:223], v[64:79]
    ds_read_b64_tr_b16 v[60:61], v8 offset:31744
    ds_read_b64_tr_b16 v[62:63], v8 offset:32000
    s_waitcnt lgkmcnt(6)
    v_mfma_f32_32x32x16_bf16 v[64:79], v[48:51], v[224:227], v[64:79]
    s_waitcnt lgkmcnt(4)
    v_mfma_f32_32x32x16_bf16 v[64:79], v[52:55], v[228:231], v[64:79]
    s_waitcnt lgkmcnt(2)
    v_mfma_f32_32x32x16_bf16 v[64:79], v[56:59], v[232:235], v[64:79]
    s_waitcnt lgkmcnt(0)
    v_mfma_f32_32x32x16_bf16 v[64:79], v[60:63], v[236:239], v[64:79]
    s_lshl_b32 s3, s40, 11
    v_add_u32 v14, s3, v12
    s_nop 11
    v_mul_f32 v64, s9, v64
    v_mul_f32 v65, s9, v65
    v_mul_f32 v66, s9, v66
    v_mul_f32 v67, s9, v67
    v_mul_f32 v68, s9, v68
    v_mul_f32 v69, s9, v69
    v_mul_f32 v70, s9, v70
    v_mul_f32 v71, s9, v71
    v_mul_f32 v72, s9, v72
    v_mul_f32 v73, s9, v73
    v_mul_f32 v74, s9, v74
    v_mul_f32 v75, s9, v75
    v_mul_f32 v76, s9, v76
    v_mul_f32 v77, s9, v77
    v_mul_f32 v78, s9, v78
    v_mul_f32 v79, s9, v79
    v_cvt_pk_bf16_f32 v16, v64, v65
    v_cvt_pk_bf16_f32 v17, v66, v67
    v_cvt_pk_bf16_f32 v18, v68, v69
    v_cvt_pk_bf16_f32 v19, v70, v71
    v_cvt_pk_bf16_f32 v20, v72, v73
    v_cvt_pk_bf16_f32 v21, v74, v75
    v_cvt_pk_bf16_f32 v22, v76, v77
    v_cvt_pk_bf16_f32 v23, v78, v79
    ds_write_b128 v14, v[16:19] offset:53248
    ds_write_b128 v14, v[20:23] offset:54272
    s_waitcnt lgkmcnt(0)
    s_barrier
    v_mov_b32 v13, v12
    s_lshr_b32 s3, s40, 1
    s_lshl_b32 s60, s42, 1
    s_add_u32 s60, s60, s3
    s_cmp_eq_u32 s3, 0
    s_cselect_b64 vcc, -1, 0
    v_cndmask_b32 v140, v28, v24, vcc
    v_cndmask_b32 v141, v29, v25, vcc
    v_cndmask_b32 v142, v30, v26, vcc
    v_cndmask_b32 v143, v31, v27, vcc
    s_and_b32 s4, s40, 1
    s_lshl_b32 s61, s41, 1
    s_add_u32 s61, s61, s4
    s_lshl_b32 s5, s4, 12
    s_lshl_b32 s6, s3, 10
    s_add_u32 s5, s5, s6
    v_add_u32 v2, s5, v13
    ds_read_b128 v[4:7], v2 offset:53248
    ds_read_b128 v[8:11], v2 offset:55296
    s_lshl_b32 s5, s60, 16
    s_add_u32 s5, s5, 4194304
    s_add_u32 s44, s34, s5
    s_addc_u32 s45, s35, 0
    s_mov_b32 s46, 65536
    s_mov_b32 s47, 0x00020000
    s_add_u32 s48, s44, 2097152
    s_addc_u32 s49, s45, 0
    s_mov_b32 s50, 65536
    s_mov_b32 s51, 0x00020000
    s_cmp_eq_u32 s4, 0
    s_cselect_b32 s52, s44, s48
    s_cselect_b32 s53, s45, s49
    s_mov_b32 s54, 65536
    s_mov_b32 s55, 0x00020000
    s_mul_i32 s70, s3, 33792
    s_lshl_b32 s71, s4, 10
    s_add_u32 s71, s71, s70
    v_and_b32 v14, 31, v1
    v_lshrrev_b32 v15, 5, v1
    v_add_u32 v2, s70, v13
    v_lshlrev_b32 v3, 8, v15
    v_lshl_add_u32 v3, v14, 4, v3
    v_add_u32 v3, 1024, v3
    v_add_u32 v12, 512, v3
    v_mov_b32 v160, 2064
    v_mov_b32 v161, 2048
    v_cmp_eq_u32 vcc, 16, v14
    v_mov_b32 v164, 0x3f803f80
    v_and_b32 v162, 1, v1
    v_cndmask_b32 v160, v160, v161, vcc
    v_cmp_gt_u32 vcc, 16, v14
    v_lshrrev_b32 v163, 1, v1
    v_mul_u32_u24 v163, 2112, v163
    v_cndmask_b32 v3, v160, v3, vcc
    v_cndmask_b32 v12, v160, v12, vcc
    v_add_u32 v3, s70, v3
    v_add_u32 v12, s70, v12
    v_cmp_eq_u32 vcc, 0, v162
    v_lshl_add_u32 v163, v162, 4, v163
    s_lshl_b32 s4, s42, 8
    v_cndmask_b32 v164, 0, v164, vcc
    v_mov_b32 v165, v164
    v_mov_b32 v166, v164
    v_mov_b32 v167, v164
    v_mov_b32 v80, 0
    v_mov_b32 v81, 0
    v_mov_b32 v82, 0
    v_mov_b32 v83, 0
    v_mov_b32 v84, 0
    v_mov_b32 v85, 0
    v_mov_b32 v86, 0
    v_mov_b32 v87, 0
    v_mov_b32 v88, 0
    v_mov_b32 v89, 0
    v_mov_b32 v90, 0
    v_mov_b32 v91, 0
    v_mov_b32 v92, 0
    v_mov_b32 v93, 0
    v_mov_b32 v94, 0
    v_mov_b32 v95, 0
    v_mov_b32 v112, 0
    v_mov_b32 v113, 0
    v_mov_b32 v114, 0
    v_mov_b32 v115, 0
    v_mov_b32 v116, 0
    v_mov_b32 v117, 0
    v_mov_b32 v118, 0
    v_mov_b32 v119, 0
    v_mov_b32 v96, 0
    v_mov_b32 v97, 0
    v_mov_b32 v98, 0
    v_mov_b32 v99, 0
    v_mov_b32 v100, 0
    v_mov_b32 v101, 0
    v_mov_b32 v102, 0
    v_mov_b32 v103, 0
    v_mov_b32 v104, 0
    v_mov_b32 v105, 0
    v_mov_b32 v106, 0
    v_mov_b32 v107, 0
    v_mov_b32 v108, 0
    v_mov_b32 v109, 0
    v_mov_b32 v110, 0
    v_mov_b32 v111, 0
    v_mov_b32 v120, 0
    v_mov_b32 v121, 0
    v_mov_b32 v122, 0
    v_mov_b32 v123, 0
    v_mov_b32 v124, 0
    v_mov_b32 v125, 0
    v_mov_b32 v126, 0
    v_mov_b32 v127, 0
    v_mov_b32 v148, 0
    v_mov_b32 v149, 0
    v_mov_b32 v150, 0
    v_mov_b32 v151, 0
    s_mov_b32 s64, 0x4e800000
    s_mov_b32 s65, 0
    s_add_u32 s4, s4, 20971520
    s_waitcnt lgkmcnt(0)
    s_barrier
    ds_write_b128 v163, v[164:167] offset:2048
    v_mfma_f32_32x32x16_bf16 v[48:63], v[140:143], v[4:7], 0
    v_mfma_f32_32x32x16_bf16 v[64:79], v[140:143], v[8:11], 0
    s_nop 13
    v_max3_f32 v168, v48, v49, v50
    v_max3_f32 v168, v168, v51, v52
    v_max3_f32 v168, v168, v53, v54
    v_max3_f32 v168, v168, v55, v56
    v_max3_f32 v168, v168, v57, v58
    v_max3_f32 v168, v168, v59, v60
    v_max3_f32 v168, v168, v61, v62
    v_max_f32 v168, v168, v63
    v_mov_b32 v169, v168
    s_nop 1
    v_permlane32_swap_b32 v169, v168
    s_nop 1
    v_max_f32 v168, v168, v169
    v_sub_f32 v16, 0xc2b00000, v168
    v_sub_f32 v17, 0xc2b00000, v168
    v_sub_f32 v18, 0xc2b00000, v168
    v_sub_f32 v19, 0xc2b00000, v168
    v_sub_f32 v20, 0xc2b00000, v168
    v_sub_f32 v21, 0xc2b00000, v168
    v_sub_f32 v22, 0xc2b00000, v168
    v_sub_f32 v23, 0xc2b00000, v168
    v_sub_f32 v24, 0xc2b00000, v168
    v_sub_f32 v25, 0xc2b00000, v168
    v_sub_f32 v26, 0xc2b00000, v168
    v_sub_f32 v27, 0xc2b00000, v168
    v_sub_f32 v28, 0xc2b00000, v168
    v_sub_f32 v29, 0xc2b00000, v168
    v_sub_f32 v30, 0xc2b00000, v168
    v_sub_f32 v31, 0xc2b00000, v168
    v_max3_f32 v168, v64, v65, v66
    v_max3_f32 v168, v168, v67, v68
    v_max3_f32 v168, v168, v69, v70
    v_max3_f32 v168, v168, v71, v72
    v_max3_f32 v168, v168, v73, v74
    v_max3_f32 v168, v168, v75, v76
    v_max3_f32 v168, v168, v77, v78
    v_max_f32 v168, v168, v79
    v_mov_b32 v169, v168
    s_nop 1
    v_permlane32_swap_b32 v169, v168
    s_nop 1
    v_max_f32 v168, v168, v169
    v_sub_f32 v32, 0xc2b00000, v168
    v_sub_f32 v33, 0xc2b00000, v168
    v_sub_f32 v34, 0xc2b00000, v168
    v_sub_f32 v35, 0xc2b00000, v168
    v_sub_f32 v36, 0xc2b00000, v168
    v_sub_f32 v37, 0xc2b00000, v168
    v_sub_f32 v38, 0xc2b00000, v168
    v_sub_f32 v39, 0xc2b00000, v168
    v_sub_f32 v40, 0xc2b00000, v168
    v_sub_f32 v41, 0xc2b00000, v168
    v_sub_f32 v42, 0xc2b00000, v168
    v_sub_f32 v43, 0xc2b00000, v168
    v_sub_f32 v44, 0xc2b00000, v168
    v_sub_f32 v45, 0xc2b00000, v168
    v_sub_f32 v46, 0xc2b00000, v168
    v_sub_f32 v47, 0xc2b00000, v168
    s_cmp_lg_u32 s40, 0
    s_cbranch_scc1 poll3_ok
    v_and_b32 v161, 63, v1
    v_lshlrev_b32 v161, 2, v161
    s_mov_b32 s3, 200000
poll3:
    buffer_load_dword v160, v161, s[36:39], s4 offen sc1
    s_waitcnt vmcnt(0)
    v_cmp_ne_u32 vcc, s83, v160
    s_cbranch_vccz poll3_ok
    s_sleep 4
    s_sub_u32 s3, s3, 1
    s_cmp_lg_u32 s3, 0
    s_cbranch_scc1 poll3
poll3_ok:
    s_waitcnt vmcnt(0)
    s_barrier
    s_setprio 1
    s_and_b32 s66, s41, 7
    s_lshl_b32 s66, s66, 13
    s_add_u32 s72, s71, 16896
    s_add_u32 s68, s66, 4096
    s_add_u32 m0, s71, 0
    s_nop 0
    buffer_load_dwordx4 v13, s[52:55], s66 offen offset:0 sc1 lds
    s_add_u32 m0, s71, 1088
    s_nop 0
    buffer_load_dwordx4 v13, s[52:55], s66 offen offset:1024 sc1 lds
    s_add_u32 m0, s71, 2176
    s_nop 0
    buffer_load_dwordx4 v13, s[52:55], s66 offen offset:2048 sc1 lds
    s_add_u32 m0, s71, 3264
    s_nop 0
    buffer_load_dwordx4 v13, s[52:55], s66 offen offset:3072 sc1 lds
    s_add_u32 m0, s71, 8448
    s_nop 0
    buffer_load_dwordx4 v13, s[52:55], s68 offen offset:0 sc1 lds
    s_add_u32 m0, s71, 9536
    s_nop 0
    buffer_load_dwordx4 v13, s[52:55], s68 offen offset:1024 sc1 lds
    s_add_u32 m0, s71, 10624
    s_nop 0
    buffer_load_dwordx4 v13, s[52:55], s68 offen offset:2048 sc1 lds
    s_add_u32 m0, s71, 11712
    s_nop 0
    buffer_load_dwordx4 v13, s[52:55], s68 offen offset:3072 sc1 lds
    s_add_u32 s66, s66, 8192
    s_and_b32 s66, s66, 65535
    s_add_u32 s68, s66, 4096
    s_add_u32 m0, s72, 0
    s_nop 0
    buffer_load_dwordx4 v13, s[52:55], s66 offen offset:0 sc1 lds
    s_waitcnt vmcnt(1) lgkmcnt(0)
    s_barrier
    ds_read_b128 v[128:131], v2 offset:0
    ds_read_b128 v[132:135], v3 offset:0
    ds_read_b128 v[136:139], v12 offset:0
    s_waitcnt lgkmcnt(0)
    v_mfma_f32_32x32x16_bf16 v[48:63], v[128:131], v[4:7], v[16:31]
    s_mov_b32 s67, 8
    s_mov_b32 s73, 16896
    s_and_b32 s74, s41, 7
    s_add_u32 s74, s74, 2
    s_nop 7
.p2align 6
at_loop:
    s_brev_b32 s75, 1
    v_exp_f32 v48, v48
    v_exp_f32 v49, v49
    v_mfma_f32_32x32x16_bf16 v[96:111], v[148:151], v[124:127], v[96:111]
    ds_read_b128 v[140:143], v2 offset:2112
    ds_read_b128 v[144:147], v3 offset:2112
    ds_read_b128 v[148:151], v12 offset:2112
    v_exp_f32 v50, v50
    v_exp_f32 v51, v51
    v_cvt_pk_bf16_f32 v112, v48, v49
    s_add_u32 m0, s72, 1088
    v_exp_f32 v52, v52
    buffer_load_dwordx4 v13, s[52:55], s66 offen offset:1024 sc1 lds
    v_exp_f32 v53, v53
    v_cvt_pk_bf16_f32 v113, v50, v51
    v_mfma_f32_32x32x16_bf16 v[64:79], v[128:131], v[8:11], v[32:47]
    v_exp_f32 v54, v54
    v_exp_f32 v55, v55
    v_cvt_pk_bf16_f32 v114, v52, v53
    v_exp_f32 v56, v56
    v_cvt_pk_bf16_f32 v115, v54, v55
    v_exp_f32 v57, v57
    v_exp_f32 v58, v58
    v_mfma_f32_32x32x16_bf16 v[80:95], v[132:135], v[112:115], v[80:95]
    v_cvt_pk_bf16_f32 v116, v56, v57
    v_exp_f32 v59, v59
    v_exp_f32 v60, v60
    v_cvt_pk_bf16_f32 v117, v58, v59
    v_exp_f32 v61, v61
    v_exp_f32 v62, v62
    v_exp_f32 v63, v63
    v_cvt_pk_bf16_f32 v118, v60, v61
    v_cvt_pk_bf16_f32 v119, v62, v63
    v_exp_f32 v64, v64
    v_exp_f32 v65, v65
    v_mfma_f32_32x32x16_bf16 v[80:95], v[136:139], v[116:119], v[80:95]
    v_exp_f32 v66, v66
    v_exp_f32 v67, v67
    v_cvt_pk_bf16_f32 v120, v64, v65
    s_add_u32 m0, s72, 2176
    v_exp_f32 v68, v68
    buffer_load_dwordx4 v13, s[52:55], s66 offen offset:2048 sc1 lds
    v_exp_f32 v69, v69
    v_cvt_pk_bf16_f32 v121, v66, v67
    s_waitcnt lgkmcnt(0)
    v_mfma_f32_32x32x16_bf16 v[48:63], v[140:143], v[4:7], v[16:31]
    v_exp_f32 v70, v70
    v_exp_f32 v71, v71
    v_cvt_pk_bf16_f32 v122, v68, v69
    v_exp_f32 v72, v72
    v_cvt_pk_bf16_f32 v123, v70, v71
    v_exp_f32 v73, v73
    v_exp_f32 v74, v74
    v_mfma_f32_32x32x16_bf16 v[96:111], v[132:135], v[120:123], v[96:111]
    v_cvt_pk_bf16_f32 v124, v72, v73
    v_exp_f32 v75, v75
    v_exp_f32 v76, v76
    v_cvt_pk_bf16_f32 v125, v74, v75
    v_exp_f32 v77, v77
    v_exp_f32 v78, v78
    v_exp_f32 v79, v79
    v_cvt_pk_bf16_f32 v126, v76, v77
    v_cvt_pk_bf16_f32 v127, v78, v79
    v_exp_f32 v48, v48
    v_exp_f32 v49, v49
    v_mfma_f32_32x32x16_bf16 v[96:111], v[136:139], v[124:127], v[96:111]
    ds_read_b128 v[128:131], v2 offset:4224
    ds_read_b128 v[132:135], v3 offset:4224
    ds_read_b128 v[136:139], v12 offset:4224
    v_exp_f32 v50, v50
    v_exp_f32 v51, v51
    v_cvt_pk_bf16_f32 v112, v48, v49
    s_add_u32 m0, s72, 3264
    v_exp_f32 v52, v52
    buffer_load_dwordx4 v13, s[52:55], s66 offen offset:3072 sc1 lds
    v_exp_f32 v53, v53
    v_cvt_pk_bf16_f32 v113, v50, v51
    v_mfma_f32_32x32x16_bf16 v[64:79], v[140:143], v[8:11], v[32:47]
    v_exp_f32 v54, v54
    v_exp_f32 v55, v55
    v_cvt_pk_bf16_f32 v114, v52, v53
    v_exp_f32 v56, v56
    v_cvt_pk_bf16_f32 v115, v54, v55
    v_exp_f32 v57, v57
    v_exp_f32 v58, v58
    v_mfma_f32_32x32x16_bf16 v[80:95], v[144:147], v[112:115], v[80:95]
    v_cvt_pk_bf16_f32 v116, v56, v57
    v_exp_f32 v59, v59
    v_exp_f32 v60, v60
    v_cvt_pk_bf16_f32 v117, v58, v59
    v_exp_f32 v61, v61
    v_exp_f32 v62, v62
    v_exp_f32 v63, v63
    v_cvt_pk_bf16_f32 v118, v60, v61
    v_cvt_pk_bf16_f32 v119, v62, v63
    v_exp_f32 v64, v64
    v_exp_f32 v65, v65
    v_mfma_f32_32x32x16_bf16 v[80:95], v[148:151], v[116:119], v[80:95]
    v_exp_f32 v66, v66
    v_exp_f32 v67, v67
    v_cvt_pk_bf16_f32 v120, v64, v65
    s_add_u32 m0, s72, 8448
    v_exp_f32 v68, v68
    buffer_load_dwordx4 v13, s[52:55], s68 offen offset:0 sc1 lds
    v_exp_f32 v69, v69
    v_cvt_pk_bf16_f32 v121, v66, v67
    s_waitcnt lgkmcnt(0)
    v_mfma_f32_32x32x16_bf16 v[48:63], v[128:131], v[4:7], v[16:31]
    v_exp_f32 v70, v70
    v_exp_f32 v71, v71
    v_cvt_pk_bf16_f32 v122, v68, v69
    v_exp_f32 v72, v72
    v_cvt_pk_bf16_f32 v123, v70, v71
    v_exp_f32 v73, v73
    v_exp_f32 v74, v74
    v_mfma_f32_32x32x16_bf16 v[96:111], v[144:147], v[120:123], v[96:111]
    v_cvt_pk_bf16_f32 v124, v72, v73
    v_exp_f32 v75, v75
    v_exp_f32 v76, v76
    v_cvt_pk_bf16_f32 v125, v74, v75
    v_exp_f32 v77, v77
    v_exp_f32 v78, v78
    v_exp_f32 v79, v79
    v_cvt_pk_bf16_f32 v126, v76, v77
    v_cvt_pk_bf16_f32 v127, v78, v79
    v_exp_f32 v48, v48
    v_exp_f32 v49, v49
    v_mfma_f32_32x32x16_bf16 v[96:111], v[148:151], v[124:127], v[96:111]
    ds_read_b128 v[140:143], v2 offset:6336
    ds_read_b128 v[144:147], v3 offset:6336
    ds_read_b128 v[148:151], v12 offset:6336
    v_exp_f32 v50, v50
    v_exp_f32 v51, v51
    v_cvt_pk_bf16_f32 v112, v48, v49
    s_add_u32 m0, s72, 9536
    v_exp_f32 v52, v52
    buffer_load_dwordx4 v13, s[52:55], s68 offen offset:1024 sc1 lds
    v_exp_f32 v53, v53
    v_cvt_pk_bf16_f32 v113, v50, v51
    v_mfma_f32_32x32x16_bf16 v[64:79], v[128:131], v[8:11], v[32:47]
    v_exp_f32 v54, v54
    v_exp_f32 v55, v55
    v_cvt_pk_bf16_f32 v114, v52, v53
    v_exp_f32 v56, v56
    v_cvt_pk_bf16_f32 v115, v54, v55
    v_exp_f32 v57, v57
    v_exp_f32 v58, v58
    v_mfma_f32_32x32x16_bf16 v[80:95], v[132:135], v[112:115], v[80:95]
    v_cvt_pk_bf16_f32 v116, v56, v57
    v_exp_f32 v59, v59
    v_exp_f32 v60, v60
    v_cvt_pk_bf16_f32 v117, v58, v59
    v_exp_f32 v61, v61
    v_exp_f32 v62, v62
    v_exp_f32 v63, v63
    v_cvt_pk_bf16_f32 v118, v60, v61
    v_cvt_pk_bf16_f32 v119, v62, v63
    v_exp_f32 v64, v64
    v_exp_f32 v65, v65
    v_mfma_f32_32x32x16_bf16 v[80:95], v[136:139], v[116:119], v[80:95]
    v_exp_f32 v66, v66
    v_exp_f32 v67, v67
    v_cvt_pk_bf16_f32 v120, v64, v65
    s_add_u32 m0, s72, 10624
    v_exp_f32 v68, v68
    buffer_load_dwordx4 v13, s[52:55], s68 offen offset:2048 sc1 lds
    v_exp_f32 v69, v69
    v_cvt_pk_bf16_f32 v121, v66, v67
    s_waitcnt lgkmcnt(0)
    v_mfma_f32_32x32x16_bf16 v[48:63], v[140:143], v[4:7], v[16:31]
    v_exp_f32 v70, v70
    v_exp_f32 v71, v71
    v_cvt_pk_bf16_f32 v122, v68, v69
    v_exp_f32 v72, v72
    v_cvt_pk_bf16_f32 v123, v70, v71
    v_exp_f32 v73, v73
    v_exp_f32 v74, v74
    v_mfma_f32_32x32x16_bf16 v[96:111], v[132:135], v[120:123], v[96:111]
    v_cvt_pk_bf16_f32 v124, v72, v73
    v_exp_f32 v75, v75
    v_exp_f32 v76, v76
    v_cvt_pk_bf16_f32 v125, v74, v75
    v_exp_f32 v77, v77
    v_exp_f32 v78, v78
    v_exp_f32 v79, v79
    v_cvt_pk_bf16_f32 v126, v76, v77
    v_cvt_pk_bf16_f32 v127, v78, v79
    v_exp_f32 v48, v48
    v_exp_f32 v49, v49
    v_mfma_f32_32x32x16_bf16 v[96:111], v[136:139], v[124:127], v[96:111]
    ds_read_b128 v[128:131], v2 offset:8448
    ds_read_b128 v[132:135], v3 offset:8448
    ds_read_b128 v[136:139], v12 offset:8448
    v_exp_f32 v50, v50
    v_exp_f32 v51, v51
    v_cvt_pk_bf16_f32 v112, v48, v49
    s_add_u32 m0, s72, 11712
    v_exp_f32 v52, v52
    buffer_load_dwordx4 v13, s[52:55], s68 offen offset:3072 sc1 lds
    v_exp_f32 v53, v53
    v_cvt_pk_bf16_f32 v113, v50, v51
    v_mfma_f32_32x32x16_bf16 v[64:79], v[140:143], v[8:11], v[32:47]
    v_exp_f32 v54, v54
    v_exp_f32 v55, v55
    v_cvt_pk_bf16_f32 v114, v52, v53
    v_exp_f32 v56, v56
    v_cvt_pk_bf16_f32 v115, v54, v55
    v_exp_f32 v57, v57
    v_exp_f32 v58, v58
    v_mfma_f32_32x32x16_bf16 v[80:95], v[144:147], v[112:115], v[80:95]
    v_cvt_pk_bf16_f32 v116, v56, v57
    v_exp_f32 v59, v59
    v_exp_f32 v60, v60
    v_cvt_pk_bf16_f32 v117, v58, v59
    v_exp_f32 v61, v61
    v_exp_f32 v62, v62
    v_exp_f32 v63, v63
    v_cvt_pk_bf16_f32 v118, v60, v61
    v_cvt_pk_bf16_f32 v119, v62, v63
    v_exp_f32 v64, v64
    v_exp_f32 v65, v65
    v_mfma_f32_32x32x16_bf16 v[80:95], v[148:151], v[116:119], v[80:95]
    v_exp_f32 v66, v66
    v_exp_f32 v67, v67
    v_cvt_pk_bf16_f32 v120, v64, v65
    v_exp_f32 v68, v68
    v_exp_f32 v69, v69
    v_cvt_pk_bf16_f32 v121, v66, v67
    s_waitcnt lgkmcnt(0)
    v_mfma_f32_32x32x16_bf16 v[48:63], v[128:131], v[4:7], v[16:31]
    v_exp_f32 v70, v70
    v_exp_f32 v71, v71
    v_cvt_pk_bf16_f32 v122, v68, v69
    v_exp_f32 v72, v72
    v_cvt_pk_bf16_f32 v123, v70, v71
    v_exp_f32 v73, v73
    v_exp_f32 v74, v74
    v_mfma_f32_32x32x16_bf16 v[96:111], v[144:147], v[120:123], v[96:111]
    v_cvt_pk_bf16_f32 v124, v72, v73
    v_exp_f32 v75, v75
    v_exp_f32 v76, v76
    v_cvt_pk_bf16_f32 v125, v74, v75
    v_exp_f32 v77, v77
    v_exp_f32 v78, v78
    v_exp_f32 v79, v79
    v_cvt_pk_bf16_f32 v126, v76, v77
    v_cvt_pk_bf16_f32 v127, v78, v79
    v_exp_f32 v48, v48
    v_exp_f32 v49, v49
    v_mfma_f32_32x32x16_bf16 v[96:111], v[148:151], v[124:127], v[96:111]
    ds_read_b128 v[140:143], v2 offset:10560
    ds_read_b128 v[144:147], v3 offset:10560
    ds_read_b128 v[148:151], v12 offset:10560
    v_exp_f32 v50, v50
    v_exp_f32 v51, v51
    v_cvt_pk_bf16_f32 v112, v48, v49
    v_exp_f32 v52, v52
    v_exp_f32 v53, v53
    v_cvt_pk_bf16_f32 v113, v50, v51
    v_mfma_f32_32x32x16_bf16 v[64:79], v[128:131], v[8:11], v[32:47]
    v_exp_f32 v54, v54
    v_exp_f32 v55, v55
    v_cvt_pk_bf16_f32 v114, v52, v53
    v_exp_f32 v56, v56
    v_cvt_pk_bf16_f32 v115, v54, v55
    v_exp_f32 v57, v57
    v_exp_f32 v58, v58
    v_mfma_f32_32x32x16_bf16 v[80:95], v[132:135], v[112:115], v[80:95]
    v_cvt_pk_bf16_f32 v116, v56, v57
    v_exp_f32 v59, v59
    v_exp_f32 v60, v60
    v_cvt_pk_bf16_f32 v117, v58, v59
    v_exp_f32 v61, v61
    v_exp_f32 v62, v62
    v_exp_f32 v63, v63
    v_cvt_pk_bf16_f32 v118, v60, v61
    v_cvt_pk_bf16_f32 v119, v62, v63
    v_exp_f32 v64, v64
    v_exp_f32 v65, v65
    v_mfma_f32_32x32x16_bf16 v[80:95], v[136:139], v[116:119], v[80:95]
    v_exp_f32 v66, v66
    v_exp_f32 v67, v67
    v_cvt_pk_bf16_f32 v120, v64, v65
    v_exp_f32 v68, v68
    v_exp_f32 v69, v69
    v_cvt_pk_bf16_f32 v121, v66, v67
    s_waitcnt lgkmcnt(0)
    v_mfma_f32_32x32x16_bf16 v[48:63], v[140:143], v[4:7], v[16:31]
    v_exp_f32 v70, v70
    v_exp_f32 v71, v71
    v_cvt_pk_bf16_f32 v122, v68, v69
    v_exp_f32 v72, v72
    v_cvt_pk_bf16_f32 v123, v70, v71
    v_exp_f32 v73, v73
    v_exp_f32 v74, v74
    v_mfma_f32_32x32x16_bf16 v[96:111], v[132:135], v[120:123], v[96:111]
    v_cvt_pk_bf16_f32 v124, v72, v73
    v_exp_f32 v75, v75
    v_exp_f32 v76, v76
    v_cvt_pk_bf16_f32 v125, v74, v75
    v_exp_f32 v77, v77
    v_exp_f32 v78, v78
    v_exp_f32 v79, v79
    v_cvt_pk_bf16_f32 v126, v76, v77
    v_cvt_pk_bf16_f32 v127, v78, v79
    v_exp_f32 v48, v48
    v_exp_f32 v49, v49
    v_mfma_f32_32x32x16_bf16 v[96:111], v[136:139], v[124:127], v[96:111]
    ds_read_b128 v[128:131], v2 offset:12672
    ds_read_b128 v[132:135], v3 offset:12672
    ds_read_b128 v[136:139], v12 offset:12672
    v_exp_f32 v50, v50
    v_exp_f32 v51, v51
    v_cvt_pk_bf16_f32 v112, v48, v49
    v_exp_f32 v52, v52
    v_exp_f32 v53, v53
    v_cvt_pk_bf16_f32 v113, v50, v51
    v_mfma_f32_32x32x16_bf16 v[64:79], v[140:143], v[8:11], v[32:47]
    v_exp_f32 v54, v54
    v_exp_f32 v55, v55
    v_cvt_pk_bf16_f32 v114, v52, v53
    v_exp_f32 v56, v56
    v_cvt_pk_bf16_f32 v115, v54, v55
    v_exp_f32 v57, v57
    v_exp_f32 v58, v58
    v_mfma_f32_32x32x16_bf16 v[80:95], v[144:147], v[112:115], v[80:95]
    v_cvt_pk_bf16_f32 v116, v56, v57
    v_exp_f32 v59, v59
    v_exp_f32 v60, v60
    v_cvt_pk_bf16_f32 v117, v58, v59
    v_exp_f32 v61, v61
    v_exp_f32 v62, v62
    v_exp_f32 v63, v63
    v_cvt_pk_bf16_f32 v118, v60, v61
    v_cvt_pk_bf16_f32 v119, v62, v63
    v_cmp_nge_f32 vcc, s64, v104
    s_cbranch_vccnz at_rareB
at_retB:
    v_exp_f32 v64, v64
    v_exp_f32 v65, v65
    v_mfma_f32_32x32x16_bf16 v[80:95], v[148:151], v[116:119], v[80:95]
    v_exp_f32 v66, v66
    v_exp_f32 v67, v67
    v_cvt_pk_bf16_f32 v120, v64, v65
    v_exp_f32 v68, v68
    v_exp_f32 v69, v69
    v_cvt_pk_bf16_f32 v121, v66, v67
    s_waitcnt lgkmcnt(0)
    v_mfma_f32_32x32x16_bf16 v[48:63], v[128:131], v[4:7], v[16:31]
    v_exp_f32 v70, v70
    v_exp_f32 v71, v71
    v_cvt_pk_bf16_f32 v122, v68, v69
    v_exp_f32 v72, v72
    v_cvt_pk_bf16_f32 v123, v70, v71
    v_exp_f32 v73, v73
    v_exp_f32 v74, v74
    v_mfma_f32_32x32x16_bf16 v[96:111], v[144:147], v[120:123], v[96:111]
    v_cvt_pk_bf16_f32 v124, v72, v73
    v_exp_f32 v75, v75
    v_exp_f32 v76, v76
    v_cvt_pk_bf16_f32 v125, v74, v75
    v_exp_f32 v77, v77
    v_exp_f32 v78, v78
    v_exp_f32 v79, v79
    v_cvt_pk_bf16_f32 v126, v76, v77
    v_cvt_pk_bf16_f32 v127, v78, v79
    v_cmp_nge_f32 vcc, s64, v88
    s_cbranch_vccnz at_rareA
at_retA:
    v_exp_f32 v48, v48
    v_exp_f32 v49, v49
    v_mfma_f32_32x32x16_bf16 v[96:111], v[148:151], v[124:127], v[96:111]
    ds_read_b128 v[140:143], v2 offset:14784
    ds_read_b128 v[144:147], v3 offset:14784
    ds_read_b128 v[148:151], v12 offset:14784
    v_exp_f32 v50, v50
    v_exp_f32 v51, v51
    v_cvt_pk_bf16_f32 v112, v48, v49
    v_exp_f32 v52, v52
    v_exp_f32 v53, v53
    v_cvt_pk_bf16_f32 v113, v50, v51
    v_mfma_f32_32x32x16_bf16 v[64:79], v[128:131], v[8:11], v[32:47]
    v_exp_f32 v54, v54
    v_exp_f32 v55, v55
    v_cvt_pk_bf16_f32 v114, v52, v53
    v_exp_f32 v56, v56
    v_cvt_pk_bf16_f32 v115, v54, v55
    v_exp_f32 v57, v57
    v_exp_f32 v58, v58
    v_mfma_f32_32x32x16_bf16 v[80:95], v[132:135], v[112:115], v[80:95]
    v_cvt_pk_bf16_f32 v116, v56, v57
    v_exp_f32 v59, v59
    v_exp_f32 v60, v60
    v_cvt_pk_bf16_f32 v117, v58, v59
    v_exp_f32 v61, v61
    v_exp_f32 v62, v62
    v_exp_f32 v63, v63
    v_cvt_pk_bf16_f32 v118, v60, v61
    v_cvt_pk_bf16_f32 v119, v62, v63
    v_exp_f32 v64, v64
    v_exp_f32 v65, v65
    v_mfma_f32_32x32x16_bf16 v[80:95], v[136:139], v[116:119], v[80:95]
    v_exp_f32 v66, v66
    v_exp_f32 v67, v67
    v_cvt_pk_bf16_f32 v120, v64, v65
    v_exp_f32 v68, v68
    v_exp_f32 v69, v69
    v_cvt_pk_bf16_f32 v121, v66, v67
    s_waitcnt lgkmcnt(0)
    v_mfma_f32_32x32x16_bf16 v[48:63], v[140:143], v[4:7], v[16:31]
    v_exp_f32 v70, v70
    v_exp_f32 v71, v71
    v_cvt_pk_bf16_f32 v122, v68, v69
    v_exp_f32 v72, v72
    v_cvt_pk_bf16_f32 v123, v70, v71
    v_exp_f32 v73, v73
    v_exp_f32 v74, v74
    v_mfma_f32_32x32x16_bf16 v[96:111], v[132:135], v[120:123], v[96:111]
    v_cvt_pk_bf16_f32 v124, v72, v73
    v_exp_f32 v75, v75
    v_exp_f32 v76, v76
    v_cvt_pk_bf16_f32 v125, v74, v75
    v_exp_f32 v77, v77
    v_exp_f32 v78, v78
    v_exp_f32 v79, v79
    v_cvt_pk_bf16_f32 v126, v76, v77
    v_cvt_pk_bf16_f32 v127, v78, v79
    v_exp_f32 v48, v48
    v_exp_f32 v49, v49
    v_mfma_f32_32x32x16_bf16 v[96:111], v[136:139], v[124:127], v[96:111]
    s_waitcnt vmcnt(0)
    s_barrier
    v_add_u32 v2, s73, v2
    v_add_u32 v3, s73, v3
    v_add_u32 v12, s73, v12
    s_sub_u32 s73, 0, s73
    s_and_b32 s66, s74, 7
    s_lshl_b32 s66, s66, 13
    s_cmp_gt_u32 s67, 2
    s_cselect_b32 s66, s66, s75
    s_add_u32 s68, s66, 4096
    s_add_u32 s74, s74, 1
    ds_read_b128 v[128:131], v2 offset:0
    ds_read_b128 v[132:135], v3 offset:0
    ds_read_b128 v[136:139], v12 offset:0
    v_exp_f32 v50, v50
    v_exp_f32 v51, v51
    v_cvt_pk_bf16_f32 v112, v48, v49
    v_exp_f32 v52, v52
    v_exp_f32 v53, v53
    v_cvt_pk_bf16_f32 v113, v50, v51
    v_mfma_f32_32x32x16_bf16 v[64:79], v[140:143], v[8:11], v[32:47]
    v_exp_f32 v54, v54
    v_exp_f32 v55, v55
    v_cvt_pk_bf16_f32 v114, v52, v53
    v_exp_f32 v56, v56
    v_cvt_pk_bf16_f32 v115, v54, v55
    v_exp_f32 v57, v57
    v_exp_f32 v58, v58
    v_mfma_f32_32x32x16_bf16 v[80:95], v[144:147], v[112:115], v[80:95]
    v_cvt_pk_bf16_f32 v116, v56, v57
    v_exp_f32 v59, v59
    v_exp_f32 v60, v60
    v_cvt_pk_bf16_f32 v117, v58, v59
    v_exp_f32 v61, v61
    v_exp_f32 v62, v62
    v_exp_f32 v63, v63
    v_cvt_pk_bf16_f32 v118, v60, v61
    v_cvt_pk_bf16_f32 v119, v62, v63
    v_exp_f32 v64, v64
    v_exp_f32 v65, v65
    v_mfma_f32_32x32x16_bf16 v[80:95], v[148:151], v[116:119], v[80:95]
    v_exp_f32 v66, v66
    v_exp_f32 v67, v67
    v_cvt_pk_bf16_f32 v120, v64, v65
    s_add_u32 m0, s71, 0
    v_exp_f32 v68, v68
    buffer_load_dwordx4 v13, s[52:55], s66 offen offset:0 sc1 lds
    v_exp_f32 v69, v69
    v_cvt_pk_bf16_f32 v121, v66, v67
    s_waitcnt lgkmcnt(0)
    v_mfma_f32_32x32x16_bf16 v[48:63], v[128:131], v[4:7], v[16:31]
    v_exp_f32 v70, v70
    v_exp_f32 v71, v71
    v_cvt_pk_bf16_f32 v122, v68, v69
    v_exp_f32 v72, v72
    v_cvt_pk_bf16_f32 v123, v70, v71
    v_exp_f32 v73, v73
    v_exp_f32 v74, v74
    v_mfma_f32_32x32x16_bf16 v[96:111], v[144:147], v[120:123], v[96:111]
    v_cvt_pk_bf16_f32 v124, v72, v73
    v_exp_f32 v75, v75
    v_exp_f32 v76, v76
    v_cvt_pk_bf16_f32 v125, v74, v75
    v_exp_f32 v77, v77
    v_exp_f32 v78, v78
    v_exp_f32 v79, v79
    v_cvt_pk_bf16_f32 v126, v76, v77
    v_cvt_pk_bf16_f32 v127, v78, v79
    s_mov_b32 s3, s71
    s_mov_b32 s71, s72
    s_mov_b32 s72, s3
    s_sub_u32 s67, s67, 1
    s_cmp_lg_u32 s67, 0
    s_cbranch_scc1 at_loop
    s_nop 1
    v_mfma_f32_32x32x16_bf16 v[96:111], v[148:151], v[124:127], v[96:111]
    s_cmp_lg_u32 s65, 0
    s_cbranch_scc1 at_safe
at_fin:
    s_nop 13
    s_mul_i32 s4, s61, 288
    s_add_u32 s4, s4, s60
    s_lshl_b32 s4, s4, 10
    s_add_u32 s4, s4, 8388608
    s_add_u32 s5, s4, 147456
    v_lshlrev_b32 v12, 4, v1
    v_mov_b32 v160, v88
    s_nop 1
    v_permlane32_swap_b32 v160, v88
    s_nop 1
    v_mul_f32 v162, 0, v160
    v_rcp_f32 v160, v160
    s_nop 0
    v_mul_f32 v80, v80, v160
    v_mul_f32 v81, v81, v160
    v_mul_f32 v82, v82, v160
    v_mul_f32 v83, v83, v160
    v_mul_f32 v84, v84, v160
    v_mul_f32 v85, v85, v160
    v_mul_f32 v86, v86, v160
    v_mul_f32 v87, v87, v160
    v_cvt_pk_bf16_f32 v112, v80, v81
    v_cvt_pk_bf16_f32 v113, v82, v83
    v_cvt_pk_bf16_f32 v114, v84, v85
    v_cvt_pk_bf16_f32 v115, v86, v87
    buffer_store_dwordx4 v[112:115], v12, s[36:39], s4 offen sc1
    v_mov_b32 v160, v104
    s_nop 1
    v_permlane32_swap_b32 v160, v104
    s_nop 1
    v_mul_f32 v163, 0, v160
    v_rcp_f32 v160, v160
    s_nop 0
    v_mul_f32 v96, v96, v160
    v_mul_f32 v97, v97, v160
    v_mul_f32 v98, v98, v160
    v_mul_f32 v99, v99, v160
    v_mul_f32 v100, v100, v160
    v_mul_f32 v101, v101, v160
    v_mul_f32 v102, v102, v160
    v_mul_f32 v103, v103, v160
    v_cvt_pk_bf16_f32 v120, v96, v97
    v_cvt_pk_bf16_f32 v121, v98, v99
    v_cvt_pk_bf16_f32 v122, v100, v101
    v_cvt_pk_bf16_f32 v123, v102, v103
    buffer_store_dwordx4 v[120:123], v12, s[36:39], s5 offen sc1
    v_fma_f32 v162, v80, 0, v162
    v_fma_f32 v162, v81, 0, v162
    v_fma_f32 v162, v82, 0, v162
    v_fma_f32 v162, v83, 0, v162
    v_fma_f32 v162, v84, 0, v162
    v_fma_f32 v162, v85, 0, v162
    v_fma_f32 v162, v86, 0, v162
    v_fma_f32 v162, v87, 0, v162
    v_fma_f32 v163, v96, 0, v163
    v_fma_f32 v163, v97, 0, v163
    v_fma_f32 v163, v98, 0, v163
    v_fma_f32 v163, v99, 0, v163
    v_fma_f32 v163, v100, 0, v163
    v_fma_f32 v163, v101, 0, v163
    v_fma_f32 v163, v102, 0, v163
    v_fma_f32 v163, v103, 0, v163
    v_cmp_u_f32 vcc, v162, v163
    s_cmp_eq_u32 s65, 0
    s_cselect_b64 s[4:5], vcc, 0
    s_cmp_lg_u64 s[4:5], 0
    s_cbranch_scc1 at_safe
    s_lshl_b32 s4, s61, 7
    s_lshl_b32 s5, s60, 2
    s_add_u32 s4, s4, s5
    s_add_u32 s4, s4, 20979712
    v_mov_b32 v160, s83
    v_mov_b32 v161, 0
    s_waitcnt vmcnt(0)
    s_mov_b64 exec, 1
    buffer_store_dword v160, v161, s[36:39], s4 offen sc1
    s_mov_b64 exec, -1
    s_endpgm
at_rareA:
    s_nop 15
    v_mov_b32 v162, 0x207
    v_cmp_class_f32 vcc, v88, v162
    s_cmp_lg_u64 vcc, 0
    s_cselect_b32 s65, 1, s65
    s_cbranch_scc1 at_retA
    v_max_f32 v160, 0x00800000, v88
    v_frexp_exp_i32_f32 v160, v160
    v_add_u32 v160, 88, v160
    v_max_i32 v160, 0, v160
    v_mov_b32 v161, v160
    s_nop 1
    v_permlane32_swap_b32 v160, v161
    s_nop 1
    v_cvt_f32_i32 v161, v160
    v_sub_u32 v160, 0, v160
    v_ldexp_f32 v80, v80, v160
    v_ldexp_f32 v81, v81, v160
    v_ldexp_f32 v82, v82, v160
    v_ldexp_f32 v83, v83, v160
    v_ldexp_f32 v84, v84, v160
    v_ldexp_f32 v85, v85, v160
    v_ldexp_f32 v86, v86, v160
    v_ldexp_f32 v87, v87, v160
    v_ldexp_f32 v88, v88, v160
    v_sub_f32 v16, v16, v161
    v_sub_f32 v17, v17, v161
    v_sub_f32 v18, v18, v161
    v_sub_f32 v19, v19, v161
    v_sub_f32 v20, v20, v161
    v_sub_f32 v21, v21, v161
    v_sub_f32 v22, v22, v161
    v_sub_f32 v23, v23, v161
    v_sub_f32 v24, v24, v161
    v_sub_f32 v25, v25, v161
    v_sub_f32 v26, v26, v161
    v_sub_f32 v27, v27, v161
    v_sub_f32 v28, v28, v161
    v_sub_f32 v29, v29, v161
    v_sub_f32 v30, v30, v161
    v_sub_f32 v31, v31, v161
    v_sub_f32 v48, v48, v161
    v_sub_f32 v49, v49, v161
    v_sub_f32 v50, v50, v161
    v_sub_f32 v51, v51, v161
    v_sub_f32 v52, v52, v161
    v_sub_f32 v53, v53, v161
    v_sub_f32 v54, v54, v161
    v_sub_f32 v55, v55, v161
    v_sub_f32 v56, v56, v161
    v_sub_f32 v57, v57, v161
    v_sub_f32 v58, v58, v161
    v_sub_f32 v59, v59, v161
    v_sub_f32 v60, v60, v161
    v_sub_f32 v61, v61, v161
    v_sub_f32 v62, v62, v161
    v_sub_f32 v63, v63, v161
    s_nop 1
    s_branch at_retA
at_rareB:
    s_nop 15
    v_mov_b32 v162, 0x207
    v_cmp_class_f32 vcc, v104, v162
    s_cmp_lg_u64 vcc, 0
    s_cselect_b32 s65, 1, s65
    s_cbranch_scc1 at_retB
    v_max_f32 v160, 0x00800000, v104
    v_frexp_exp_i32_f32 v160, v160
    v_add_u32 v160, 88, v160
    v_max_i32 v160, 0, v160
    v_mov_b32 v161, v160
    s_nop 1
    v_permlane32_swap_b32 v160, v161
    s_nop 1
    v_cvt_f32_i32 v161, v160
    v_sub_u32 v160, 0, v160
    v_ldexp_f32 v96, v96, v160
    v_ldexp_f32 v97, v97, v160
    v_ldexp_f32 v98, v98, v160
    v_ldexp_f32 v99, v99, v160
    v_ldexp_f32 v100, v100, v160
    v_ldexp_f32 v101, v101, v160
    v_ldexp_f32 v102, v102, v160
    v_ldexp_f32 v103, v103, v160
    v_ldexp_f32 v104, v104, v160
    v_sub_f32 v32, v32, v161
    v_sub_f32 v33, v33, v161
    v_sub_f32 v34, v34, v161
    v_sub_f32 v35, v35, v161
    v_sub_f32 v36, v36, v161
    v_sub_f32 v37, v37, v161
    v_sub_f32 v38, v38, v161
    v_sub_f32 v39, v39, v161
    v_sub_f32 v40, v40, v161
    v_sub_f32 v41, v41, v161
    v_sub_f32 v42, v42, v161
    v_sub_f32 v43, v43, v161
    v_sub_f32 v44, v44, v161
    v_sub_f32 v45, v45, v161
    v_sub_f32 v46, v46, v161
    v_sub_f32 v47, v47, v161
    v_sub_f32 v64, v64, v161
    v_sub_f32 v65, v65, v161
    v_sub_f32 v66, v66, v161
    v_sub_f32 v67, v67, v161
    v_sub_f32 v68, v68, v161
    v_sub_f32 v69, v69, v161
    v_sub_f32 v70, v70, v161
    v_sub_f32 v71, v71, v161
    v_sub_f32 v72, v72, v161
    v_sub_f32 v73, v73, v161
    v_sub_f32 v74, v74, v161
    v_sub_f32 v75, v75, v161
    v_sub_f32 v76, v76, v161
    v_sub_f32 v77, v77, v161
    v_sub_f32 v78, v78, v161
    v_sub_f32 v79, v79, v161
    s_nop 1
    s_branch at_retB
at_safe:
    s_waitcnt vmcnt(0) lgkmcnt(0)
    s_nop 15
    s_mov_b32 s65, 2
    v_and_b32 v14, 31, v1
    v_lshrrev_b32 v15, 5, v1
    v_lshlrev_b32 v3, 8, v15
    v_lshl_add_u32 v3, v14, 4, v3
    v_mov_b32 v15, 0x3f803f80
    v_cmp_eq_u32 vcc, 16, v14
    s_mov_b32 s62, 0x0000ffff
    s_mov_b32 s63, 0x0000ffff
    v_cndmask_b32 v15, 0, v15, vcc
    v_mov_b32 v132, v15
    v_mov_b32 v133, v15
    v_mov_b32 v134, v15
    v_mov_b32 v135, v15
    v_mov_b32 v136, v15
    v_mov_b32 v137, v15
    v_mov_b32 v138, v15
    v_mov_b32 v139, v15
    v_mov_b32 v80, 0
    v_mov_b32 v81, 0
    v_mov_b32 v82, 0
    v_mov_b32 v83, 0
    v_mov_b32 v84, 0
    v_mov_b32 v85, 0
    v_mov_b32 v86, 0
    v_mov_b32 v87, 0
    v_mov_b32 v88, 0
    v_mov_b32 v89, 0
    v_mov_b32 v90, 0
    v_mov_b32 v91, 0
    v_mov_b32 v92, 0
    v_mov_b32 v93, 0
    v_mov_b32 v94, 0
    v_mov_b32 v95, 0
    v_mov_b32 v16, 0xff800000
    v_mov_b32 v96, 0
    v_mov_b32 v97, 0
    v_mov_b32 v98, 0
    v_mov_b32 v99, 0
    v_mov_b32 v100, 0
    v_mov_b32 v101, 0
    v_mov_b32 v102, 0
    v_mov_b32 v103, 0
    v_mov_b32 v104, 0
    v_mov_b32 v105, 0
    v_mov_b32 v106, 0
    v_mov_b32 v107, 0
    v_mov_b32 v108, 0
    v_mov_b32 v109, 0
    v_mov_b32 v110, 0
    v_mov_b32 v111, 0
    v_mov_b32 v32, 0xff800000
    s_mov_b32 s66, 0
    s_mov_b32 s67, 64
at_sloop:
    buffer_load_dwordx4 v[128:131], v13, s[44:47], s66 offen offset:0 sc1
    s_mov_b64 exec, s[62:63]
    buffer_load_dwordx4 v[132:135], v3, s[48:51], s66 offen offset:0 sc1
    buffer_load_dwordx4 v[136:139], v3, s[48:51], s66 offen offset:512 sc1
    s_mov_b64 exec, -1
    s_waitcnt vmcnt(0)
    v_mfma_f32_32x32x16_bf16 v[48:63], v[128:131], v[4:7], 0
    v_mfma_f32_32x32x16_bf16 v[64:79], v[128:131], v[8:11], 0
    s_nop 15
    v_max3_f32 v160, v48, v49, v50
    v_max3_f32 v160, v160, v51, v52
    v_max3_f32 v160, v160, v53, v54
    v_max3_f32 v160, v160, v55, v56
    v_max3_f32 v160, v160, v57, v58
    v_max3_f32 v160, v160, v59, v60
    v_max3_f32 v160, v160, v61, v62
    v_max_f32 v160, v160, v63
    v_mov_b32 v161, v160
    s_nop 1
    v_permlane32_swap_b32 v161, v160
    s_nop 1
    v_max3_f32 v160, v160, v161, v16
    v_sub_f32 v161, v16, v160
    v_exp_f32 v161, v161
    v_mov_b32 v16, v160
    v_mul_f32 v80, v80, v161
    v_mul_f32 v81, v81, v161
    v_mul_f32 v82, v82, v161
    v_mul_f32 v83, v83, v161
    v_mul_f32 v84, v84, v161
    v_mul_f32 v85, v85, v161
    v_mul_f32 v86, v86, v161
    v_mul_f32 v87, v87, v161
    v_mul_f32 v88, v88, v161
    v_sub_f32 v48, v48, v160
    v_sub_f32 v49, v49, v160
    v_sub_f32 v50, v50, v160
    v_sub_f32 v51, v51, v160
    v_sub_f32 v52, v52, v160
    v_sub_f32 v53, v53, v160
    v_sub_f32 v54, v54, v160
    v_sub_f32 v55, v55, v160
    v_sub_f32 v56, v56, v160
    v_sub_f32 v57, v57, v160
    v_sub_f32 v58, v58, v160
    v_sub_f32 v59, v59, v160
    v_sub_f32 v60, v60, v160
    v_sub_f32 v61, v61, v160
    v_sub_f32 v62, v62, v160
    v_sub_f32 v63, v63, v160
    v_exp_f32 v48, v48
    v_exp_f32 v49, v49
    v_exp_f32 v50, v50
    v_exp_f32 v51, v51
    v_exp_f32 v52, v52
    v_exp_f32 v53, v53
    v_exp_f32 v54, v54
    v_exp_f32 v55, v55
    v_exp_f32 v56, v56
    v_exp_f32 v57, v57
    v_exp_f32 v58, v58
    v_exp_f32 v59, v59
    v_exp_f32 v60, v60
    v_exp_f32 v61, v61
    v_exp_f32 v62, v62
    v_exp_f32 v63, v63
    s_nop 0
    v_cvt_pk_bf16_f32 v112, v48, v49
    v_cvt_pk_bf16_f32 v113, v50, v51
    v_cvt_pk_bf16_f32 v114, v52, v53
    v_cvt_pk_bf16_f32 v115, v54, v55
    v_cvt_pk_bf16_f32 v116, v56, v57
    v_cvt_pk_bf16_f32 v117, v58, v59
    v_cvt_pk_bf16_f32 v118, v60, v61
    v_cvt_pk_bf16_f32 v119, v62, v63
    s_nop 1
    v_mfma_f32_32x32x16_bf16 v[80:95], v[132:135], v[112:115], v[80:95]
    v_mfma_f32_32x32x16_bf16 v[80:95], v[136:139], v[116:119], v[80:95]
    v_max3_f32 v160, v64, v65, v66
    v_max3_f32 v160, v160, v67, v68
    v_max3_f32 v160, v160, v69, v70
    v_max3_f32 v160, v160, v71, v72
    v_max3_f32 v160, v160, v73, v74
    v_max3_f32 v160, v160, v75, v76
    v_max3_f32 v160, v160, v77, v78
    v_max_f32 v160, v160, v79
    v_mov_b32 v161, v160
    s_nop 1
    v_permlane32_swap_b32 v161, v160
    s_nop 1
    v_max3_f32 v160, v160, v161, v32
    v_sub_f32 v161, v32, v160
    v_exp_f32 v161, v161
    v_mov_b32 v32, v160
    v_mul_f32 v96, v96, v161
    v_mul_f32 v97, v97, v161
    v_mul_f32 v98, v98, v161
    v_mul_f32 v99, v99, v161
    v_mul_f32 v100, v100, v161
    v_mul_f32 v101, v101, v161
    v_mul_f32 v102, v102, v161
    v_mul_f32 v103, v103, v161
    v_mul_f32 v104, v104, v161
    v_sub_f32 v64, v64, v160
    v_sub_f32 v65, v65, v160
    v_sub_f32 v66, v66, v160
    v_sub_f32 v67, v67, v160
    v_sub_f32 v68, v68, v160
    v_sub_f32 v69, v69, v160
    v_sub_f32 v70, v70, v160
    v_sub_f32 v71, v71, v160
    v_sub_f32 v72, v72, v160
    v_sub_f32 v73, v73, v160
    v_sub_f32 v74, v74, v160
    v_sub_f32 v75, v75, v160
    v_sub_f32 v76, v76, v160
    v_sub_f32 v77, v77, v160
    v_sub_f32 v78, v78, v160
    v_sub_f32 v79, v79, v160
    v_exp_f32 v64, v64
    v_exp_f32 v65, v65
    v_exp_f32 v66, v66
    v_exp_f32 v67, v67
    v_exp_f32 v68, v68
    v_exp_f32 v69, v69
    v_exp_f32 v70, v70
    v_exp_f32 v71, v71
    v_exp_f32 v72, v72
    v_exp_f32 v73, v73
    v_exp_f32 v74, v74
    v_exp_f32 v75, v75
    v_exp_f32 v76, v76
    v_exp_f32 v77, v77
    v_exp_f32 v78, v78
    v_exp_f32 v79, v79
    s_nop 0
    v_cvt_pk_bf16_f32 v120, v64, v65
    v_cvt_pk_bf16_f32 v121, v66, v67
    v_cvt_pk_bf16_f32 v122, v68, v69
    v_cvt_pk_bf16_f32 v123, v70, v71
    v_cvt_pk_bf16_f32 v124, v72, v73
    v_cvt_pk_bf16_f32 v125, v74, v75
    v_cvt_pk_bf16_f32 v126, v76, v77
    v_cvt_pk_bf16_f32 v127, v78, v79
    s_nop 1
    v_mfma_f32_32x32x16_bf16 v[96:111], v[132:135], v[120:123], v[96:111]
    v_mfma_f32_32x32x16_bf16 v[96:111], v[136:139], v[124:127], v[96:111]
    s_nop 15
    s_add_u32 s66, s66, 1024
    s_sub_u32 s67, s67, 1
    s_cmp_lg_u32 s67, 0
    s_cbranch_scc1 at_sloop
    s_branch at_fin
parallel_sum__mha_block__swiglu_ffn__prompt_kernel_B:
    s_setprio 3
    s_mov_b32 s44, s16
    s_mov_b32 s45, s17
    s_mov_b32 s46, 2097152
    s_mov_b32 s47, 0x00020000
    s_lshl_b32 s3, s41, 7
    s_lshl_b32 s4, s42, 3
    s_add_u32 s3, s3, s4
    s_lshl_b32 s4, s40, 1
    s_add_u32 s3, s3, s4
    s_lshl_b32 s3, s3, 10
    v_lshlrev_b32 v2, 4, v1
    buffer_load_dwordx4 v[208:211], v2, s[44:47], s3 offen
    buffer_load_dwordx4 v[212:215], v2, s[44:47], s3 offen offset:1024
    v_mov_b32 v247, 0
    buffer_load_dword v246, v247, s[56:59], 0 offen sc1
    s_and_b32 s3, s40, 1
    s_lshr_b32 s4, s40, 1
    v_lshrrev_b32 v16, 2, v1
    v_and_b32 v17, 3, v1
    v_mul_u32_u24 v6, 3584, v16
    v_lshl_add_u32 v6, v17, 4, v6
    s_cmp_eq_u32 s4, 0
    s_cselect_b32 s48, s24, s26
    s_cselect_b32 s49, s25, s27
    s_mov_b32 s50, 1835008
    s_mov_b32 s51, 0x00020000
    s_mul_i32 s64, s42, 224
    s_mul_i32 s5, s3, 57344
    s_add_u32 s64, s64, s5
    s_lshl_b32 s5, s4, 11
    s_lshl_b32 s6, s3, 10
    s_add_u32 s68, s5, s6
    s_lshl_b32 s5, s4, 10
    s_add_u32 s5, s5, 12288
    s_add_u32 s6, s68, 8192
    s_cmp_eq_u32 s3, 0
    s_cselect_b32 s71, s5, s6
    s_cselect_b64 s[14:15], -1, 1
    s_and_b32 s7, s42, 1
    s_lshl_b32 s8, s7, 5
    v_add_u32 v6, s8, v6
    s_cmp_eq_u32 s7, 0
    s_cselect_b32 s8, 192, 0
    v_lshrrev_b32 v18, 1, v1
    s_lshl_b32 s9, s4, 2
    v_xor_b32 v18, s9, v18
    v_mul_u32_u24 v18, 3584, v18
    v_and_b32 v19, 1, v1
    v_lshl_add_u32 v18, v19, 4, v18
    v_add_u32 v18, s8, v18
    v_add_u32 v19, 128, v6
    s_cmp_eq_u32 s3, 0
    s_cselect_b64 vcc, -1, 0
    v_cndmask_b32 v7, v19, v18, vcc
    s_and_b32 s10, s41, 7
    s_and_b32 s11, s42, 3
    s_lshl_b32 s11, s11, 1
    s_add_u32 s10, s10, s11
    s_and_b32 s74, s10, 7
    s_mul_i32 s11, s74, 229376
    s_add_u32 s64, s64, s11
    s_sub_u32 s67, 8, s74
    v_lshlrev_b32 v240, 7, v1
    s_lshl_b32 s3, s40, 5
    v_add_u32 v240, s3, v240
    v_lshlrev_b32 v241, 4, v1
    s_lshl_b32 s3, s40, 12
    v_add_u32 v241, s3, v241
    v_lshrrev_b32 v242, 3, v1
    v_lshrrev_b32 v243, 1, v242
    v_lshlrev_b32 v243, 10, v243
    v_and_b32 v242, 1, v242
    v_lshl_add_u32 v243, v242, 9, v243
    v_and_b32 v242, 7, v1
    v_lshl_add_u32 v243, v242, 4, v243
    s_lshl_b32 s3, s41, 2
    s_lshr_b32 s4, s42, 2
    s_add_u32 s5, s3, s4
    s_lshl_b32 s60, s5, 15
    s_and_b32 s4, s42, 3
    s_lshl_b32 s6, s4, 7
    s_add_u32 s60, s60, s6
    s_lshl_b32 s6, s40, 14
    s_add_u32 s60, s60, s6
    s_lshl_b32 s5, s5, 6
    s_lshl_b32 s4, s4, 4
    s_add_u32 s5, s5, s4
    s_lshl_b32 s4, s40, 3
    s_add_u32 s5, s5, s4
    s_add_u32 s66, s5, 20983808
    s_waitcnt vmcnt(0)
    v_readfirstlane_b32 s83, v246
    v_lshlrev_b32 v216, 16, v208
    v_and_b32 v217, 0xffff0000, v208
    v_lshlrev_b32 v218, 16, v209
    v_and_b32 v219, 0xffff0000, v209
    v_lshlrev_b32 v220, 16, v210
    v_and_b32 v221, 0xffff0000, v210
    v_lshlrev_b32 v222, 16, v211
    v_and_b32 v223, 0xffff0000, v211
    v_lshlrev_b32 v224, 16, v212
    v_and_b32 v225, 0xffff0000, v212
    v_lshlrev_b32 v226, 16, v213
    v_and_b32 v227, 0xffff0000, v213
    v_lshlrev_b32 v228, 16, v214
    v_and_b32 v229, 0xffff0000, v214
    v_lshlrev_b32 v230, 16, v215
    v_and_b32 v231, 0xffff0000, v215
    v_add_f32 v232, v216, v217
    v_mul_f32 v234, v216, v216
    v_add_f32 v233, v224, v225
    v_mul_f32 v235, v224, v224
    v_fmac_f32 v234, v217, v217
    v_fmac_f32 v235, v225, v225
    v_add_f32 v232, v232, v218
    v_fmac_f32 v234, v218, v218
    v_add_f32 v233, v233, v226
    v_fmac_f32 v235, v226, v226
    v_add_f32 v232, v232, v219
    v_fmac_f32 v234, v219, v219
    v_add_f32 v233, v233, v227
    v_fmac_f32 v235, v227, v227
    v_add_f32 v232, v232, v220
    v_fmac_f32 v234, v220, v220
    v_add_f32 v233, v233, v228
    v_fmac_f32 v235, v228, v228
    v_add_f32 v232, v232, v221
    v_fmac_f32 v234, v221, v221
    v_add_f32 v233, v233, v229
    v_fmac_f32 v235, v229, v229
    v_add_f32 v232, v232, v222
    v_fmac_f32 v234, v222, v222
    v_add_f32 v233, v233, v230
    v_fmac_f32 v235, v230, v230
    v_add_f32 v232, v232, v223
    v_fmac_f32 v234, v223, v223
    v_add_f32 v233, v233, v231
    v_fmac_f32 v235, v231, v231
    ds_swizzle_b32 v236, v232 offset:1055
    ds_swizzle_b32 v237, v233 offset:1055
    ds_swizzle_b32 v238, v234 offset:1055
    ds_swizzle_b32 v239, v235 offset:1055
    s_waitcnt lgkmcnt(0)
    v_add_f32 v232, v232, v236
    v_add_f32 v233, v233, v237
    v_add_f32 v234, v234, v238
    v_add_f32 v235, v235, v239
    ds_swizzle_b32 v236, v232 offset:2079
    ds_swizzle_b32 v237, v233 offset:2079
    ds_swizzle_b32 v238, v234 offset:2079
    ds_swizzle_b32 v239, v235 offset:2079
    s_waitcnt lgkmcnt(0)
    v_add_f32 v232, v232, v236
    v_add_f32 v233, v233, v237
    v_add_f32 v234, v234, v238
    v_add_f32 v235, v235, v239
    ds_swizzle_b32 v236, v232 offset:4127
    ds_swizzle_b32 v237, v233 offset:4127
    ds_swizzle_b32 v238, v234 offset:4127
    ds_swizzle_b32 v239, v235 offset:4127
    s_waitcnt lgkmcnt(0)
    v_add_f32 v232, v232, v236
    v_add_f32 v233, v233, v237
    v_add_f32 v234, v234, v238
    v_add_f32 v235, v235, v239
    ds_swizzle_b32 v236, v232 offset:8223
    ds_swizzle_b32 v237, v233 offset:8223
    ds_swizzle_b32 v238, v234 offset:8223
    ds_swizzle_b32 v239, v235 offset:8223
    s_waitcnt lgkmcnt(0)
    v_add_f32 v232, v232, v236
    v_add_f32 v233, v233, v237
    v_add_f32 v234, v234, v238
    v_add_f32 v235, v235, v239
    ds_swizzle_b32 v236, v232 offset:16415
    ds_swizzle_b32 v237, v233 offset:16415
    ds_swizzle_b32 v238, v234 offset:16415
    ds_swizzle_b32 v239, v235 offset:16415
    s_waitcnt lgkmcnt(0)
    v_add_f32 v232, v232, v236
    v_add_f32 v233, v233, v237
    v_add_f32 v234, v234, v238
    v_add_f32 v235, v235, v239
    v_mov_b32 v236, v232
    v_mov_b32 v237, v233
    v_mov_b32 v238, v234
    v_mov_b32 v239, v235
    s_nop 1
    v_permlane32_swap_b32 v236, v232
    v_permlane32_swap_b32 v237, v233
    v_permlane32_swap_b32 v238, v234
    v_permlane32_swap_b32 v239, v235
    s_nop 1
    v_add_f32 v232, v232, v236
    v_add_f32 v233, v233, v237
    v_add_f32 v234, v234, v238
    v_add_f32 v235, v235, v239
    v_mul_f32 v232, 0x3b000000, v232
    v_mul_f32 v233, 0x3b000000, v233
    v_mul_f32 v234, 0x3b000000, v234
    v_mul_f32 v235, 0x3b000000, v235
    v_fma_f32 v234, -v232, v232, v234
    v_fma_f32 v235, -v233, v233, v235
    v_max_f32 v234, 0, v234
    v_max_f32 v235, 0, v235
    v_cvt_pk_bf16_f32 v236, v232, v232
    v_cvt_pk_bf16_f32 v237, v233, v233
    v_cvt_pk_bf16_f32 v238, v234, v234
    v_cvt_pk_bf16_f32 v239, v235, v235
    v_lshlrev_b32 v232, 16, v236
    v_lshlrev_b32 v233, 16, v237
    v_lshlrev_b32 v234, 16, v238
    v_lshlrev_b32 v235, 16, v239
    v_add_f32 v234, 0x3727c5ac, v234
    v_add_f32 v235, 0x3727c5ac, v235
    v_cvt_pk_bf16_f32 v236, v234, v234
    v_cvt_pk_bf16_f32 v237, v235, v235
    v_lshlrev_b32 v234, 16, v236
    v_lshlrev_b32 v235, 16, v237
    v_sqrt_f32 v234, v234
    v_sqrt_f32 v235, v235
    s_nop 0
    v_cvt_pk_bf16_f32 v236, v234, v234
    v_cvt_pk_bf16_f32 v237, v235, v235
    v_lshlrev_b32 v234, 16, v236
    v_lshlrev_b32 v235, 16, v237
    v_rcp_f32 v234, v234
    v_rcp_f32 v235, v235
    v_sub_f32 v216, v216, v232
    v_sub_f32 v217, v217, v232
    v_sub_f32 v218, v218, v232
    v_sub_f32 v219, v219, v232
    v_sub_f32 v220, v220, v232
    v_sub_f32 v221, v221, v232
    v_sub_f32 v222, v222, v232
    v_sub_f32 v223, v223, v232
    v_sub_f32 v224, v224, v233
    v_sub_f32 v225, v225, v233
    v_sub_f32 v226, v226, v233
    v_sub_f32 v227, v227, v233
    v_sub_f32 v228, v228, v233
    v_sub_f32 v229, v229, v233
    v_sub_f32 v230, v230, v233
    v_sub_f32 v231, v231, v233
    v_cvt_pk_bf16_f32 v208, v216, v217
    v_cvt_pk_bf16_f32 v209, v218, v219
    v_cvt_pk_bf16_f32 v210, v220, v221
    v_cvt_pk_bf16_f32 v211, v222, v223
    v_cvt_pk_bf16_f32 v212, v224, v225
    v_cvt_pk_bf16_f32 v213, v226, v227
    v_cvt_pk_bf16_f32 v214, v228, v229
    v_cvt_pk_bf16_f32 v215, v230, v231
    v_lshlrev_b32 v216, 16, v208
    v_and_b32 v217, 0xffff0000, v208
    v_lshlrev_b32 v218, 16, v209
    v_and_b32 v219, 0xffff0000, v209
    v_lshlrev_b32 v220, 16, v210
    v_and_b32 v221, 0xffff0000, v210
    v_lshlrev_b32 v222, 16, v211
    v_and_b32 v223, 0xffff0000, v211
    v_lshlrev_b32 v224, 16, v212
    v_and_b32 v225, 0xffff0000, v212
    v_lshlrev_b32 v226, 16, v213
    v_and_b32 v227, 0xffff0000, v213
    v_lshlrev_b32 v228, 16, v214
    v_and_b32 v229, 0xffff0000, v214
    v_lshlrev_b32 v230, 16, v215
    v_and_b32 v231, 0xffff0000, v215
    v_mul_f32 v216, v216, v234
    v_mul_f32 v217, v217, v234
    v_mul_f32 v218, v218, v234
    v_mul_f32 v219, v219, v234
    v_mul_f32 v220, v220, v234
    v_mul_f32 v221, v221, v234
    v_mul_f32 v222, v222, v234
    v_mul_f32 v223, v223, v234
    v_mul_f32 v224, v224, v235
    v_mul_f32 v225, v225, v235
    v_mul_f32 v226, v226, v235
    v_mul_f32 v227, v227, v235
    v_mul_f32 v228, v228, v235
    v_mul_f32 v229, v229, v235
    v_mul_f32 v230, v230, v235
    v_mul_f32 v231, v231, v235
    v_cvt_pk_bf16_f32 v208, v216, v217
    v_cvt_pk_bf16_f32 v209, v218, v219
    v_cvt_pk_bf16_f32 v210, v220, v221
    v_cvt_pk_bf16_f32 v211, v222, v223
    v_cvt_pk_bf16_f32 v212, v224, v225
    v_cvt_pk_bf16_f32 v213, v226, v227
    v_cvt_pk_bf16_f32 v214, v228, v229
    v_cvt_pk_bf16_f32 v215, v230, v231
    ds_write_b128 v240, v[208:211] offset:43008
    ds_write_b128 v240, v[212:215] offset:43024
    s_cmp_lg_u32 s83, 0
    s_cbranch_scc1 ln_have_nonce
    v_mov_b32 v245, 0
    s_mov_b32 s3, 200000
nonce4:
    buffer_load_dword v244, v245, s[56:59], 0 offen sc1
    s_waitcnt vmcnt(0)
    v_readfirstlane_b32 s83, v244
    s_sub_u32 s3, s3, 1
    s_cmp_eq_u32 s3, 0
    s_cbranch_scc1 nonce4_ok
    s_cmp_lg_u32 s83, 0
    s_cbranch_scc1 nonce4_ok
    s_sleep 8
    s_branch nonce4
nonce4_ok:
ln_have_nonce:
    s_waitcnt lgkmcnt(0)
    s_barrier
    s_cmp_ge_u32 s40, 2
    s_cbranch_scc1 ln_done
    ds_read_b128 v[208:211], v241 offset:43008
    ds_read_b128 v[212:215], v241 offset:44032
    ds_read_b128 v[216:219], v241 offset:45056
    ds_read_b128 v[220:223], v241 offset:46080
    v_mov_b32 v244, s83
    v_mov_b32 v245, s83
    s_waitcnt lgkmcnt(3)
    buffer_store_dwordx4 v[208:211], v243, s[36:39], s60 offen sc1
    s_add_u32 s60, s60, 4096
    s_waitcnt lgkmcnt(2)
    buffer_store_dwordx4 v[212:215], v243, s[36:39], s60 offen sc1
    s_add_u32 s60, s60, 4096
    s_waitcnt lgkmcnt(1)
    buffer_store_dwordx4 v[216:219], v243, s[36:39], s60 offen sc1
    s_add_u32 s60, s60, 4096
    s_waitcnt lgkmcnt(0)
    buffer_store_dwordx4 v[220:223], v243, s[36:39], s60 offen sc1
    s_waitcnt vmcnt(0)
    s_mov_b64 exec, 1
    buffer_store_dwordx2 v[244:245], v247, s[36:39], s66 offen sc1
    s_mov_b64 exec, -1
    s_add_u32 s64, s64, 114688
    s_add_u32 s64, s64, 114688
    s_sub_u32 s67, s67, 1
    s_cmp_eq_u32 s67, 0
    s_cselect_b32 s10, 1835008, 0
    s_sub_u32 s64, s64, s10
    s_add_u32 s64, s64, 114688
    s_branch g1B_pro
ln_done:
    s_mov_b32 s52, s24
    s_mov_b32 s53, s25
    s_mov_b32 s54, 1835008
    s_mov_b32 s55, 0x00020000
    v_lshrrev_b32 v18, 1, v1
    v_mul_u32_u24 v18, 3584, v18
    v_and_b32 v20, 1, v1
    v_lshl_add_u32 v18, v20, 4, v18
    v_add_u32 v18, s8, v18
    s_sub_u32 s69, s68, 2048
    s_add_u32 s6, s69, 8192
    s_and_b32 s3, s40, 1
    s_cmp_eq_u32 s3, 0
    s_cselect_b32 s70, 12288, s6
    s_cselect_b64 vcc, -1, 0
    v_cndmask_b32 v11, v19, v18, vcc
    s_add_u32 m0, s69, 0
    s_nop 0
    buffer_load_dwordx4 v6, s[52:55], s64 offen offset:0 lds
    s_add_u32 m0, s69, 4032
    s_nop 0
    buffer_load_dwordx4 v6, s[52:55], s64 offen offset:64 lds
    s_add_u32 m0, s69, 8064
    s_nop 0
    buffer_load_dwordx4 v6, s[52:55], s64 offen offset:128 lds
    s_add_u32 m0, s70, 0
    s_mov_b64 exec, s[14:15]
    buffer_load_dwordx4 v11, s[52:55], s64 offen lds
    s_mov_b64 exec, -1
    s_add_u32 m0, s68, 0
    s_nop 0
    buffer_load_dwordx4 v6, s[48:51], s64 offen offset:0 lds
    s_add_u32 m0, s68, 4032
    s_nop 0
    buffer_load_dwordx4 v6, s[48:51], s64 offen offset:64 lds
    s_add_u32 m0, s68, 8064
    s_nop 0
    buffer_load_dwordx4 v6, s[48:51], s64 offen offset:128 lds
    s_add_u32 m0, s71, 0
    s_nop 0
    s_mov_b64 exec, s[14:15]
    buffer_load_dwordx4 v7, s[48:51], s64 offen lds
    s_mov_b64 exec, -1
    s_add_u32 s64, s64, 114688
    s_add_u32 m0, s69, 14336
    s_nop 0
    buffer_load_dwordx4 v6, s[52:55], s64 offen offset:0 lds
    s_add_u32 m0, s69, 18368
    s_nop 0
    buffer_load_dwordx4 v6, s[52:55], s64 offen offset:64 lds
    s_add_u32 m0, s69, 22400
    s_nop 0
    buffer_load_dwordx4 v6, s[52:55], s64 offen offset:128 lds
    s_add_u32 m0, s70, 14336
    s_mov_b64 exec, s[14:15]
    buffer_load_dwordx4 v11, s[52:55], s64 offen lds
    s_mov_b64 exec, -1
    s_add_u32 m0, s68, 14336
    s_nop 0
    buffer_load_dwordx4 v6, s[48:51], s64 offen offset:0 lds
    s_add_u32 m0, s68, 18368
    s_nop 0
    buffer_load_dwordx4 v6, s[48:51], s64 offen offset:64 lds
    s_add_u32 m0, s68, 22400
    s_nop 0
    buffer_load_dwordx4 v6, s[48:51], s64 offen offset:128 lds
    s_add_u32 m0, s71, 14336
    s_nop 0
    s_mov_b64 exec, s[14:15]
    buffer_load_dwordx4 v7, s[48:51], s64 offen lds
    s_mov_b64 exec, -1
    s_add_u32 s64, s64, 114688
    s_sub_u32 s67, s67, 1
    s_cmp_eq_u32 s67, 0
    s_cselect_b32 s10, 1835008, 0
    s_sub_u32 s64, s64, s10
    s_add_u32 m0, s69, 28672
    s_nop 0
    buffer_load_dwordx4 v6, s[52:55], s64 offen offset:0 lds
    s_add_u32 m0, s69, 32704
    s_nop 0
    buffer_load_dwordx4 v6, s[52:55], s64 offen offset:64 lds
    s_add_u32 m0, s69, 36736
    s_nop 0
    buffer_load_dwordx4 v6, s[52:55], s64 offen offset:128 lds
    s_add_u32 m0, s70, 28672
    s_mov_b64 exec, s[14:15]
    buffer_load_dwordx4 v11, s[52:55], s64 offen lds
    s_mov_b64 exec, -1
    s_add_u32 m0, s68, 28672
    s_nop 0
    buffer_load_dwordx4 v6, s[48:51], s64 offen offset:0 lds
    s_add_u32 m0, s68, 32704
    s_nop 0
    buffer_load_dwordx4 v6, s[48:51], s64 offen offset:64 lds
    s_add_u32 m0, s68, 36736
    s_nop 0
    buffer_load_dwordx4 v6, s[48:51], s64 offen offset:128 lds
    s_add_u32 m0, s71, 28672
    s_nop 0
    s_mov_b64 exec, s[14:15]
    buffer_load_dwordx4 v7, s[48:51], s64 offen lds
    s_mov_b64 exec, -1
    s_add_u32 s64, s64, 114688
g1B_pro:
    v_lshrrev_b32 v17, 5, v1
    v_bfe_u32 v18, v1, 2, 2
    v_lshl_add_u32 v18, v17, 3, v18
    v_and_b32 v19, 3, v1
    v_bfe_u32 v20, v1, 4, 1
    v_lshlrev_b32 v8, 6, v18
    v_lshl_add_u32 v8, v20, 5, v8
    v_lshl_add_u32 v8, v19, 3, v8
    v_lshlrev_b32 v21, 2, v20
    v_xor_b32 v21, v21, v18
    v_lshlrev_b32 v9, 5, v21
    v_lshl_add_u32 v9, v20, 10, v9
    v_lshl_add_u32 v9, v19, 3, v9
    v_add_u32 v9, 12288, v9
    v_xor_b32 v10, 128, v9
    v_mov_b32 v100, 0
    v_mov_b32 v101, 0
    v_mov_b32 v102, 0
    v_mov_b32 v103, 0
    v_mov_b32 v104, 0
    v_mov_b32 v105, 0
    v_mov_b32 v106, 0
    v_mov_b32 v107, 0
    v_mov_b32 v108, 0
    v_mov_b32 v109, 0
    v_mov_b32 v110, 0
    v_mov_b32 v111, 0
    v_mov_b32 v112, 0
    v_mov_b32 v113, 0
    v_mov_b32 v114, 0
    v_mov_b32 v115, 0
    v_mov_b32 v116, 0
    v_mov_b32 v117, 0
    v_mov_b32 v118, 0
    v_mov_b32 v119, 0
    v_mov_b32 v120, 0
    v_mov_b32 v121, 0
    v_mov_b32 v122, 0
    v_mov_b32 v123, 0
    v_mov_b32 v124, 0
    v_mov_b32 v125, 0
    v_mov_b32 v126, 0
    v_mov_b32 v127, 0
    v_mov_b32 v128, 0
    v_mov_b32 v129, 0
    v_mov_b32 v130, 0
    v_mov_b32 v131, 0
    v_mov_b32 v132, 0
    v_mov_b32 v133, 0
    v_mov_b32 v134, 0
    v_mov_b32 v135, 0
    v_mov_b32 v136, 0
    v_mov_b32 v137, 0
    v_mov_b32 v138, 0
    v_mov_b32 v139, 0
    v_mov_b32 v140, 0
    v_mov_b32 v141, 0
    v_mov_b32 v142, 0
    v_mov_b32 v143, 0
    v_mov_b32 v144, 0
    v_mov_b32 v145, 0
    v_mov_b32 v146, 0
    v_mov_b32 v147, 0
    v_mov_b32 v148, 0
    v_mov_b32 v149, 0
    v_mov_b32 v150, 0
    v_mov_b32 v151, 0
    v_mov_b32 v152, 0
    v_mov_b32 v153, 0
    v_mov_b32 v154, 0
    v_mov_b32 v155, 0
    v_mov_b32 v156, 0
    v_mov_b32 v157, 0
    v_mov_b32 v158, 0
    v_mov_b32 v159, 0
    v_mov_b32 v160, 0
    v_mov_b32 v161, 0
    v_mov_b32 v162, 0
    v_mov_b32 v163, 0
    v_mov_b32 v164, 0
    v_mov_b32 v165, 0
    v_mov_b32 v166, 0
    v_mov_b32 v167, 0
    v_mov_b32 v168, 0
    v_mov_b32 v169, 0
    v_mov_b32 v170, 0
    v_mov_b32 v171, 0
    v_mov_b32 v172, 0
    v_mov_b32 v173, 0
    v_mov_b32 v174, 0
    v_mov_b32 v175, 0
    v_mov_b32 v176, 0
    v_mov_b32 v177, 0
    v_mov_b32 v178, 0
    v_mov_b32 v179, 0
    v_mov_b32 v180, 0
    v_mov_b32 v181, 0
    v_mov_b32 v182, 0
    v_mov_b32 v183, 0
    v_mov_b32 v184, 0
    v_mov_b32 v185, 0
    v_mov_b32 v186, 0
    v_mov_b32 v187, 0
    v_mov_b32 v188, 0
    v_mov_b32 v189, 0
    v_mov_b32 v190, 0
    v_mov_b32 v191, 0
    v_mov_b32 v192, 0
    v_mov_b32 v193, 0
    v_mov_b32 v194, 0
    v_mov_b32 v195, 0
    v_mov_b32 v196, 0
    v_mov_b32 v197, 0
    v_mov_b32 v198, 0
    v_mov_b32 v199, 0
    v_mov_b32 v200, 0
    v_mov_b32 v201, 0
    v_mov_b32 v202, 0
    v_mov_b32 v203, 0
    v_mov_b32 v204, 0
    v_mov_b32 v205, 0
    v_mov_b32 v206, 0
    v_mov_b32 v207, 0
    v_mov_b32 v208, 0
    v_mov_b32 v209, 0
    v_mov_b32 v210, 0
    v_mov_b32 v211, 0
    s_setprio 0
    s_lshl_b32 s43, s41, 2
    s_add_u32 s43, s43, s40
    s_lshl_b32 s4, s41, 8
    s_add_u32 s4, s4, 20983808
    s_cmp_lg_u32 s40, 0
    s_cbranch_scc1 poll5_ok
    v_and_b32 v241, 63, v1
    v_lshlrev_b32 v241, 2, v241
    s_mov_b32 s3, 200000
poll5:
    buffer_load_dword v240, v241, s[36:39], s4 offen sc1
    s_waitcnt vmcnt(0)
    v_cmp_ne_u32 vcc, s83, v240
    s_cbranch_vccz poll5_ok
    s_sleep 4
    s_sub_u32 s3, s3, 1
    s_cmp_lg_u32 s3, 0
    s_cbranch_scc1 poll5
poll5_ok:
    s_waitcnt vmcnt(0)
    s_barrier
    s_lshl_b32 s70, s43, 15
    s_lshl_b32 s73, s74, 12
    s_add_u32 s72, s70, s73
    buffer_load_dwordx4 v[12:15], v2, s[36:39], s72 offen offset:0 sc1
    buffer_load_dwordx4 v[16:19], v2, s[36:39], s72 offen offset:1024 sc1
    buffer_load_dwordx4 v[20:23], v2, s[36:39], s72 offen offset:2048 sc1
    buffer_load_dwordx4 v[24:27], v2, s[36:39], s72 offen offset:3072 sc1
    s_add_u32 s73, s73, 4096
    s_and_b32 s73, s73, 32767
    s_add_u32 s72, s70, s73
    buffer_load_dwordx4 v[28:31], v2, s[36:39], s72 offen offset:0 sc1
    buffer_load_dwordx4 v[32:35], v2, s[36:39], s72 offen offset:1024 sc1
    s_waitcnt vmcnt(4)
    s_barrier
    ds_read_b64_tr_b16 v[44:45], v8 offset:0
    ds_read_b64_tr_b16 v[46:47], v8 offset:256
    ds_read_b64_tr_b16 v[48:49], v8 offset:2048
    ds_read_b64_tr_b16 v[50:51], v8 offset:2304
    ds_read_b64_tr_b16 v[52:53], v8 offset:4096
    ds_read_b64_tr_b16 v[54:55], v8 offset:4352
    ds_read_b64_tr_b16 v[56:57], v8 offset:6144
    ds_read_b64_tr_b16 v[58:59], v8 offset:6400
    ds_read_b64_tr_b16 v[60:61], v8 offset:8192
    ds_read_b64_tr_b16 v[62:63], v8 offset:8448
    ds_read_b64_tr_b16 v[64:65], v8 offset:10240
    ds_read_b64_tr_b16 v[66:67], v8 offset:10496
    ds_read_b64_tr_b16 v[68:69], v9 offset:0
    ds_read_b64_tr_b16 v[70:71], v10 offset:0
    s_waitcnt lgkmcnt(10)
    v_mfma_f32_32x32x16_bf16 v[100:115], v[44:47], v[12:15], v[100:115]
    ds_read_b64_tr_b16 v[72:73], v8 offset:1024
    ds_read_b64_tr_b16 v[74:75], v8 offset:1280
    v_mfma_f32_32x32x16_bf16 v[116:131], v[48:51], v[12:15], v[116:131]
    ds_read_b64_tr_b16 v[76:77], v8 offset:3072
    ds_read_b64_tr_b16 v[78:79], v8 offset:3328
    s_waitcnt lgkmcnt(10)
    v_mfma_f32_32x32x16_bf16 v[132:147], v[52:55], v[12:15], v[132:147]
    ds_read_b64_tr_b16 v[80:81], v8 offset:5120
    ds_read_b64_tr_b16 v[82:83], v8 offset:5376
    v_mfma_f32_32x32x16_bf16 v[148:163], v[56:59], v[12:15], v[148:163]
    ds_read_b64_tr_b16 v[84:85], v8 offset:7168
    ds_read_b64_tr_b16 v[86:87], v8 offset:7424
    s_waitcnt lgkmcnt(10)
    v_mfma_f32_32x32x16_bf16 v[164:179], v[60:63], v[12:15], v[164:179]
    ds_read_b64_tr_b16 v[88:89], v8 offset:9216
    ds_read_b64_tr_b16 v[90:91], v8 offset:9472
    v_mfma_f32_32x32x16_bf16 v[180:195], v[64:67], v[12:15], v[180:195]
    ds_read_b64_tr_b16 v[92:93], v8 offset:11264
    ds_read_b64_tr_b16 v[94:95], v8 offset:11520
    s_waitcnt lgkmcnt(12)
    v_mfma_f32_32x32x16_bf16 v[196:211], v[68:71], v[12:15], v[196:211]
    ds_read_b64_tr_b16 v[96:97], v9 offset:512
    ds_read_b64_tr_b16 v[98:99], v10 offset:512
    s_waitcnt vmcnt(2)
    s_barrier
    s_waitcnt lgkmcnt(10)
    v_mfma_f32_32x32x16_bf16 v[100:115], v[72:75], v[16:19], v[100:115]
    ds_read_b64_tr_b16 v[44:45], v8 offset:14336
    ds_read_b64_tr_b16 v[46:47], v8 offset:14592
    s_add_u32 m0, s68, 43008
    v_mfma_f32_32x32x16_bf16 v[116:131], v[76:79], v[16:19], v[116:131]
    ds_read_b64_tr_b16 v[48:49], v8 offset:16384
    ds_read_b64_tr_b16 v[50:51], v8 offset:16640
    buffer_load_dwordx4 v6, s[48:51], s64 offen offset:0 lds
    s_waitcnt lgkmcnt(10)
    s_add_u32 m0, s68, 47040
    v_mfma_f32_32x32x16_bf16 v[132:147], v[80:83], v[16:19], v[132:147]
    ds_read_b64_tr_b16 v[52:53], v8 offset:18432
    ds_read_b64_tr_b16 v[54:55], v8 offset:18688
    buffer_load_dwordx4 v6, s[48:51], s64 offen offset:64 lds
    s_add_u32 m0, s68, 51072
    v_mfma_f32_32x32x16_bf16 v[148:163], v[84:87], v[16:19], v[148:163]
    ds_read_b64_tr_b16 v[56:57], v8 offset:20480
    ds_read_b64_tr_b16 v[58:59], v8 offset:20736
    buffer_load_dwordx4 v6, s[48:51], s64 offen offset:128 lds
    s_waitcnt lgkmcnt(10)
    s_add_u32 m0, s71, 43008
    v_mfma_f32_32x32x16_bf16 v[164:179], v[88:91], v[16:19], v[164:179]
    ds_read_b64_tr_b16 v[60:61], v8 offset:22528
    ds_read_b64_tr_b16 v[62:63], v8 offset:22784
    s_mov_b64 exec, s[14:15]
    buffer_load_dwordx4 v7, s[48:51], s64 offen lds
    s_mov_b64 exec, -1
    s_add_u32 s64, s64, 114688
    s_sub_u32 s67, s67, 1
    s_cmp_eq_u32 s67, 0
    s_cselect_b32 s10, 1835008, 0
    s_sub_u32 s64, s64, s10
    v_mfma_f32_32x32x16_bf16 v[180:195], v[92:95], v[16:19], v[180:195]
    ds_read_b64_tr_b16 v[64:65], v8 offset:24576
    ds_read_b64_tr_b16 v[66:67], v8 offset:24832
    buffer_load_dwordx4 v[36:39], v2, s[36:39], s72 offen offset:2048 sc1
    s_waitcnt lgkmcnt(12)
    v_mfma_f32_32x32x16_bf16 v[196:211], v[96:99], v[16:19], v[196:211]
    ds_read_b64_tr_b16 v[68:69], v9 offset:14336
    ds_read_b64_tr_b16 v[70:71], v10 offset:14336
    buffer_load_dwordx4 v[40:43], v2, s[36:39], s72 offen offset:3072 sc1
    s_add_u32 s73, s73, 4096
    s_and_b32 s73, s73, 32767
    s_add_u32 s72, s70, s73
    s_waitcnt lgkmcnt(10)
    v_mfma_f32_32x32x16_bf16 v[100:115], v[44:47], v[20:23], v[100:115]
    ds_read_b64_tr_b16 v[72:73], v8 offset:15360
    ds_read_b64_tr_b16 v[74:75], v8 offset:15616
    v_mfma_f32_32x32x16_bf16 v[116:131], v[48:51], v[20:23], v[116:131]
    ds_read_b64_tr_b16 v[76:77], v8 offset:17408
    ds_read_b64_tr_b16 v[78:79], v8 offset:17664
    s_waitcnt lgkmcnt(10)
    v_mfma_f32_32x32x16_bf16 v[132:147], v[52:55], v[20:23], v[132:147]
    ds_read_b64_tr_b16 v[80:81], v8 offset:19456
    ds_read_b64_tr_b16 v[82:83], v8 offset:19712
    v_mfma_f32_32x32x16_bf16 v[148:163], v[56:59], v[20:23], v[148:163]
    ds_read_b64_tr_b16 v[84:85], v8 offset:21504
    ds_read_b64_tr_b16 v[86:87], v8 offset:21760
    s_waitcnt lgkmcnt(10)
    v_mfma_f32_32x32x16_bf16 v[164:179], v[60:63], v[20:23], v[164:179]
    ds_read_b64_tr_b16 v[88:89], v8 offset:23552
    ds_read_b64_tr_b16 v[90:91], v8 offset:23808
    v_mfma_f32_32x32x16_bf16 v[180:195], v[64:67], v[20:23], v[180:195]
    ds_read_b64_tr_b16 v[92:93], v8 offset:25600
    ds_read_b64_tr_b16 v[94:95], v8 offset:25856
    s_waitcnt lgkmcnt(12)
    v_mfma_f32_32x32x16_bf16 v[196:211], v[68:71], v[20:23], v[196:211]
    ds_read_b64_tr_b16 v[96:97], v9 offset:14848
    ds_read_b64_tr_b16 v[98:99], v10 offset:14848
    s_waitcnt vmcnt(6)
    s_barrier
    s_waitcnt lgkmcnt(10)
    v_mfma_f32_32x32x16_bf16 v[100:115], v[72:75], v[24:27], v[100:115]
    ds_read_b64_tr_b16 v[44:45], v8 offset:28672
    ds_read_b64_tr_b16 v[46:47], v8 offset:28928
    s_add_u32 m0, s68, 0
    v_mfma_f32_32x32x16_bf16 v[116:131], v[76:79], v[24:27], v[116:131]
    ds_read_b64_tr_b16 v[48:49], v8 offset:30720
    ds_read_b64_tr_b16 v[50:51], v8 offset:30976
    buffer_load_dwordx4 v6, s[48:51], s64 offen offset:0 lds
    s_waitcnt lgkmcnt(10)
    s_add_u32 m0, s68, 4032
    v_mfma_f32_32x32x16_bf16 v[132:147], v[80:83], v[24:27], v[132:147]
    ds_read_b64_tr_b16 v[52:53], v8 offset:32768
    ds_read_b64_tr_b16 v[54:55], v8 offset:33024
    buffer_load_dwordx4 v6, s[48:51], s64 offen offset:64 lds
    s_add_u32 m0, s68, 8064
    v_mfma_f32_32x32x16_bf16 v[148:163], v[84:87], v[24:27], v[148:163]
    ds_read_b64_tr_b16 v[56:57], v8 offset:34816
    ds_read_b64_tr_b16 v[58:59], v8 offset:35072
    buffer_load_dwordx4 v6, s[48:51], s64 offen offset:128 lds
    s_waitcnt lgkmcnt(10)
    s_add_u32 m0, s71, 0
    v_mfma_f32_32x32x16_bf16 v[164:179], v[88:91], v[24:27], v[164:179]
    ds_read_b64_tr_b16 v[60:61], v8 offset:36864
    ds_read_b64_tr_b16 v[62:63], v8 offset:37120
    s_mov_b64 exec, s[14:15]
    buffer_load_dwordx4 v7, s[48:51], s64 offen lds
    s_mov_b64 exec, -1
    s_add_u32 s64, s64, 114688
    v_mfma_f32_32x32x16_bf16 v[180:195], v[92:95], v[24:27], v[180:195]
    ds_read_b64_tr_b16 v[64:65], v8 offset:38912
    ds_read_b64_tr_b16 v[66:67], v8 offset:39168
    buffer_load_dwordx4 v[12:15], v2, s[36:39], s72 offen offset:0 sc1
    s_waitcnt lgkmcnt(12)
    v_mfma_f32_32x32x16_bf16 v[196:211], v[96:99], v[24:27], v[196:211]
    ds_read_b64_tr_b16 v[68:69], v9 offset:28672
    ds_read_b64_tr_b16 v[70:71], v10 offset:28672
    buffer_load_dwordx4 v[16:19], v2, s[36:39], s72 offen offset:1024 sc1
    s_waitcnt lgkmcnt(10)
    v_mfma_f32_32x32x16_bf16 v[100:115], v[44:47], v[28:31], v[100:115]
    ds_read_b64_tr_b16 v[72:73], v8 offset:29696
    ds_read_b64_tr_b16 v[74:75], v8 offset:29952
    v_mfma_f32_32x32x16_bf16 v[116:131], v[48:51], v[28:31], v[116:131]
    ds_read_b64_tr_b16 v[76:77], v8 offset:31744
    ds_read_b64_tr_b16 v[78:79], v8 offset:32000
    s_waitcnt lgkmcnt(10)
    v_mfma_f32_32x32x16_bf16 v[132:147], v[52:55], v[28:31], v[132:147]
    ds_read_b64_tr_b16 v[80:81], v8 offset:33792
    ds_read_b64_tr_b16 v[82:83], v8 offset:34048
    v_mfma_f32_32x32x16_bf16 v[148:163], v[56:59], v[28:31], v[148:163]
    ds_read_b64_tr_b16 v[84:85], v8 offset:35840
    ds_read_b64_tr_b16 v[86:87], v8 offset:36096
    s_waitcnt lgkmcnt(10)
    v_mfma_f32_32x32x16_bf16 v[164:179], v[60:63], v[28:31], v[164:179]
    ds_read_b64_tr_b16 v[88:89], v8 offset:37888
    ds_read_b64_tr_b16 v[90:91], v8 offset:38144
    v_mfma_f32_32x32x16_bf16 v[180:195], v[64:67], v[28:31], v[180:195]
    ds_read_b64_tr_b16 v[92:93], v8 offset:39936
    ds_read_b64_tr_b16 v[94:95], v8 offset:40192
    s_waitcnt lgkmcnt(12)
    v_mfma_f32_32x32x16_bf16 v[196:211], v[68:71], v[28:31], v[196:211]
    ds_read_b64_tr_b16 v[96:97], v9 offset:29184
    ds_read_b64_tr_b16 v[98:99], v10 offset:29184
    s_waitcnt vmcnt(6)
    s_barrier
    s_waitcnt lgkmcnt(10)
    v_mfma_f32_32x32x16_bf16 v[100:115], v[72:75], v[32:35], v[100:115]
    ds_read_b64_tr_b16 v[44:45], v8 offset:43008
    ds_read_b64_tr_b16 v[46:47], v8 offset:43264
    s_add_u32 m0, s68, 14336
    v_mfma_f32_32x32x16_bf16 v[116:131], v[76:79], v[32:35], v[116:131]
    ds_read_b64_tr_b16 v[48:49], v8 offset:45056
    ds_read_b64_tr_b16 v[50:51], v8 offset:45312
    buffer_load_dwordx4 v6, s[48:51], s64 offen offset:0 lds
    s_waitcnt lgkmcnt(10)
    s_add_u32 m0, s68, 18368
    v_mfma_f32_32x32x16_bf16 v[132:147], v[80:83], v[32:35], v[132:147]
    ds_read_b64_tr_b16 v[52:53], v8 offset:47104
    ds_read_b64_tr_b16 v[54:55], v8 offset:47360
    buffer_load_dwordx4 v6, s[48:51], s64 offen offset:64 lds
    s_add_u32 m0, s68, 22400
    v_mfma_f32_32x32x16_bf16 v[148:163], v[84:87], v[32:35], v[148:163]
    ds_read_b64_tr_b16 v[56:57], v8 offset:49152
    ds_read_b64_tr_b16 v[58:59], v8 offset:49408
    buffer_load_dwordx4 v6, s[48:51], s64 offen offset:128 lds
    s_waitcnt lgkmcnt(10)
    s_add_u32 m0, s71, 14336
    v_mfma_f32_32x32x16_bf16 v[164:179], v[88:91], v[32:35], v[164:179]
    ds_read_b64_tr_b16 v[60:61], v8 offset:51200
    ds_read_b64_tr_b16 v[62:63], v8 offset:51456
    s_mov_b64 exec, s[14:15]
    buffer_load_dwordx4 v7, s[48:51], s64 offen lds
    s_mov_b64 exec, -1
    s_add_u32 s64, s64, 114688
    s_sub_u32 s67, s67, 1
    s_cmp_eq_u32 s67, 0
    s_cselect_b32 s10, 1835008, 0
    s_sub_u32 s64, s64, s10
    v_mfma_f32_32x32x16_bf16 v[180:195], v[92:95], v[32:35], v[180:195]
    ds_read_b64_tr_b16 v[64:65], v8 offset:53248
    ds_read_b64_tr_b16 v[66:67], v8 offset:53504
    buffer_load_dwordx4 v[20:23], v2, s[36:39], s72 offen offset:2048 sc1
    s_waitcnt lgkmcnt(12)
    v_mfma_f32_32x32x16_bf16 v[196:211], v[96:99], v[32:35], v[196:211]
    ds_read_b64_tr_b16 v[68:69], v9 offset:43008
    ds_read_b64_tr_b16 v[70:71], v10 offset:43008
    buffer_load_dwordx4 v[24:27], v2, s[36:39], s72 offen offset:3072 sc1
    s_add_u32 s73, s73, 4096
    s_and_b32 s73, s73, 32767
    s_add_u32 s72, s70, s73
    s_waitcnt lgkmcnt(10)
    v_mfma_f32_32x32x16_bf16 v[100:115], v[44:47], v[36:39], v[100:115]
    ds_read_b64_tr_b16 v[72:73], v8 offset:44032
    ds_read_b64_tr_b16 v[74:75], v8 offset:44288
    v_mfma_f32_32x32x16_bf16 v[116:131], v[48:51], v[36:39], v[116:131]
    ds_read_b64_tr_b16 v[76:77], v8 offset:46080
    ds_read_b64_tr_b16 v[78:79], v8 offset:46336
    s_waitcnt lgkmcnt(10)
    v_mfma_f32_32x32x16_bf16 v[132:147], v[52:55], v[36:39], v[132:147]
    ds_read_b64_tr_b16 v[80:81], v8 offset:48128
    ds_read_b64_tr_b16 v[82:83], v8 offset:48384
    v_mfma_f32_32x32x16_bf16 v[148:163], v[56:59], v[36:39], v[148:163]
    ds_read_b64_tr_b16 v[84:85], v8 offset:50176
    ds_read_b64_tr_b16 v[86:87], v8 offset:50432
    s_waitcnt lgkmcnt(10)
    v_mfma_f32_32x32x16_bf16 v[164:179], v[60:63], v[36:39], v[164:179]
    ds_read_b64_tr_b16 v[88:89], v8 offset:52224
    ds_read_b64_tr_b16 v[90:91], v8 offset:52480
    v_mfma_f32_32x32x16_bf16 v[180:195], v[64:67], v[36:39], v[180:195]
    ds_read_b64_tr_b16 v[92:93], v8 offset:54272
    ds_read_b64_tr_b16 v[94:95], v8 offset:54528
    s_waitcnt lgkmcnt(12)
    v_mfma_f32_32x32x16_bf16 v[196:211], v[68:71], v[36:39], v[196:211]
    ds_read_b64_tr_b16 v[96:97], v9 offset:43520
    ds_read_b64_tr_b16 v[98:99], v10 offset:43520
    s_waitcnt vmcnt(6)
    s_barrier
    s_waitcnt lgkmcnt(10)
    v_mfma_f32_32x32x16_bf16 v[100:115], v[72:75], v[40:43], v[100:115]
    ds_read_b64_tr_b16 v[44:45], v8 offset:0
    ds_read_b64_tr_b16 v[46:47], v8 offset:256
    s_add_u32 m0, s68, 28672
    v_mfma_f32_32x32x16_bf16 v[116:131], v[76:79], v[40:43], v[116:131]
    ds_read_b64_tr_b16 v[48:49], v8 offset:2048
    ds_read_b64_tr_b16 v[50:51], v8 offset:2304
    buffer_load_dwordx4 v6, s[48:51], s64 offen offset:0 lds
    s_waitcnt lgkmcnt(10)
    s_add_u32 m0, s68, 32704
    v_mfma_f32_32x32x16_bf16 v[132:147], v[80:83], v[40:43], v[132:147]
    ds_read_b64_tr_b16 v[52:53], v8 offset:4096
    ds_read_b64_tr_b16 v[54:55], v8 offset:4352
    buffer_load_dwordx4 v6, s[48:51], s64 offen offset:64 lds
    s_add_u32 m0, s68, 36736
    v_mfma_f32_32x32x16_bf16 v[148:163], v[84:87], v[40:43], v[148:163]
    ds_read_b64_tr_b16 v[56:57], v8 offset:6144
    ds_read_b64_tr_b16 v[58:59], v8 offset:6400
    buffer_load_dwordx4 v6, s[48:51], s64 offen offset:128 lds
    s_waitcnt lgkmcnt(10)
    s_add_u32 m0, s71, 28672
    v_mfma_f32_32x32x16_bf16 v[164:179], v[88:91], v[40:43], v[164:179]
    ds_read_b64_tr_b16 v[60:61], v8 offset:8192
    ds_read_b64_tr_b16 v[62:63], v8 offset:8448
    s_mov_b64 exec, s[14:15]
    buffer_load_dwordx4 v7, s[48:51], s64 offen lds
    s_mov_b64 exec, -1
    s_add_u32 s64, s64, 114688
    v_mfma_f32_32x32x16_bf16 v[180:195], v[92:95], v[40:43], v[180:195]
    ds_read_b64_tr_b16 v[64:65], v8 offset:10240
    ds_read_b64_tr_b16 v[66:67], v8 offset:10496
    buffer_load_dwordx4 v[28:31], v2, s[36:39], s72 offen offset:0 sc1
    s_waitcnt lgkmcnt(12)
    v_mfma_f32_32x32x16_bf16 v[196:211], v[96:99], v[40:43], v[196:211]
    ds_read_b64_tr_b16 v[68:69], v9 offset:0
    ds_read_b64_tr_b16 v[70:71], v10 offset:0
    buffer_load_dwordx4 v[32:35], v2, s[36:39], s72 offen offset:1024 sc1
    s_mov_b32 s75, 2
.p2align 6
g1B_loop:
    s_waitcnt lgkmcnt(10)
    v_mfma_f32_32x32x16_bf16 v[100:115], v[44:47], v[12:15], v[100:115]
    ds_read_b64_tr_b16 v[72:73], v8 offset:1024
    ds_read_b64_tr_b16 v[74:75], v8 offset:1280
    v_mfma_f32_32x32x16_bf16 v[116:131], v[48:51], v[12:15], v[116:131]
    ds_read_b64_tr_b16 v[76:77], v8 offset:3072
    ds_read_b64_tr_b16 v[78:79], v8 offset:3328
    s_waitcnt lgkmcnt(10)
    v_mfma_f32_32x32x16_bf16 v[132:147], v[52:55], v[12:15], v[132:147]
    ds_read_b64_tr_b16 v[80:81], v8 offset:5120
    ds_read_b64_tr_b16 v[82:83], v8 offset:5376
    v_mfma_f32_32x32x16_bf16 v[148:163], v[56:59], v[12:15], v[148:163]
    ds_read_b64_tr_b16 v[84:85], v8 offset:7168
    ds_read_b64_tr_b16 v[86:87], v8 offset:7424
    s_waitcnt lgkmcnt(10)
    v_mfma_f32_32x32x16_bf16 v[164:179], v[60:63], v[12:15], v[164:179]
    ds_read_b64_tr_b16 v[88:89], v8 offset:9216
    ds_read_b64_tr_b16 v[90:91], v8 offset:9472
    v_mfma_f32_32x32x16_bf16 v[180:195], v[64:67], v[12:15], v[180:195]
    ds_read_b64_tr_b16 v[92:93], v8 offset:11264
    ds_read_b64_tr_b16 v[94:95], v8 offset:11520
    s_waitcnt lgkmcnt(12)
    v_mfma_f32_32x32x16_bf16 v[196:211], v[68:71], v[12:15], v[196:211]
    ds_read_b64_tr_b16 v[96:97], v9 offset:512
    ds_read_b64_tr_b16 v[98:99], v10 offset:512
    s_waitcnt vmcnt(6)
    s_barrier
    s_waitcnt lgkmcnt(10)
    v_mfma_f32_32x32x16_bf16 v[100:115], v[72:75], v[16:19], v[100:115]
    ds_read_b64_tr_b16 v[44:45], v8 offset:14336
    ds_read_b64_tr_b16 v[46:47], v8 offset:14592
    s_add_u32 m0, s68, 43008
    v_mfma_f32_32x32x16_bf16 v[116:131], v[76:79], v[16:19], v[116:131]
    ds_read_b64_tr_b16 v[48:49], v8 offset:16384
    ds_read_b64_tr_b16 v[50:51], v8 offset:16640
    buffer_load_dwordx4 v6, s[48:51], s64 offen offset:0 lds
    s_waitcnt lgkmcnt(10)
    s_add_u32 m0, s68, 47040
    v_mfma_f32_32x32x16_bf16 v[132:147], v[80:83], v[16:19], v[132:147]
    ds_read_b64_tr_b16 v[52:53], v8 offset:18432
    ds_read_b64_tr_b16 v[54:55], v8 offset:18688
    buffer_load_dwordx4 v6, s[48:51], s64 offen offset:64 lds
    s_add_u32 m0, s68, 51072
    v_mfma_f32_32x32x16_bf16 v[148:163], v[84:87], v[16:19], v[148:163]
    ds_read_b64_tr_b16 v[56:57], v8 offset:20480
    ds_read_b64_tr_b16 v[58:59], v8 offset:20736
    buffer_load_dwordx4 v6, s[48:51], s64 offen offset:128 lds
    s_waitcnt lgkmcnt(10)
    s_add_u32 m0, s71, 43008
    v_mfma_f32_32x32x16_bf16 v[164:179], v[88:91], v[16:19], v[164:179]
    ds_read_b64_tr_b16 v[60:61], v8 offset:22528
    ds_read_b64_tr_b16 v[62:63], v8 offset:22784
    s_mov_b64 exec, s[14:15]
    buffer_load_dwordx4 v7, s[48:51], s64 offen lds
    s_mov_b64 exec, -1
    s_add_u32 s64, s64, 114688
    s_sub_u32 s67, s67, 1
    s_cmp_eq_u32 s67, 0
    s_cselect_b32 s10, 1835008, 0
    s_sub_u32 s64, s64, s10
    v_mfma_f32_32x32x16_bf16 v[180:195], v[92:95], v[16:19], v[180:195]
    ds_read_b64_tr_b16 v[64:65], v8 offset:24576
    ds_read_b64_tr_b16 v[66:67], v8 offset:24832
    buffer_load_dwordx4 v[36:39], v2, s[36:39], s72 offen offset:2048 sc1
    s_waitcnt lgkmcnt(12)
    v_mfma_f32_32x32x16_bf16 v[196:211], v[96:99], v[16:19], v[196:211]
    ds_read_b64_tr_b16 v[68:69], v9 offset:14336
    ds_read_b64_tr_b16 v[70:71], v10 offset:14336
    buffer_load_dwordx4 v[40:43], v2, s[36:39], s72 offen offset:3072 sc1
    s_add_u32 s73, s73, 4096
    s_and_b32 s73, s73, 32767
    s_add_u32 s72, s70, s73
    s_waitcnt lgkmcnt(10)
    v_mfma_f32_32x32x16_bf16 v[100:115], v[44:47], v[20:23], v[100:115]
    ds_read_b64_tr_b16 v[72:73], v8 offset:15360
    ds_read_b64_tr_b16 v[74:75], v8 offset:15616
    v_mfma_f32_32x32x16_bf16 v[116:131], v[48:51], v[20:23], v[116:131]
    ds_read_b64_tr_b16 v[76:77], v8 offset:17408
    ds_read_b64_tr_b16 v[78:79], v8 offset:17664
    s_waitcnt lgkmcnt(10)
    v_mfma_f32_32x32x16_bf16 v[132:147], v[52:55], v[20:23], v[132:147]
    ds_read_b64_tr_b16 v[80:81], v8 offset:19456
    ds_read_b64_tr_b16 v[82:83], v8 offset:19712
    v_mfma_f32_32x32x16_bf16 v[148:163], v[56:59], v[20:23], v[148:163]
    ds_read_b64_tr_b16 v[84:85], v8 offset:21504
    ds_read_b64_tr_b16 v[86:87], v8 offset:21760
    s_waitcnt lgkmcnt(10)
    v_mfma_f32_32x32x16_bf16 v[164:179], v[60:63], v[20:23], v[164:179]
    ds_read_b64_tr_b16 v[88:89], v8 offset:23552
    ds_read_b64_tr_b16 v[90:91], v8 offset:23808
    v_mfma_f32_32x32x16_bf16 v[180:195], v[64:67], v[20:23], v[180:195]
    ds_read_b64_tr_b16 v[92:93], v8 offset:25600
    ds_read_b64_tr_b16 v[94:95], v8 offset:25856
    s_waitcnt lgkmcnt(12)
    v_mfma_f32_32x32x16_bf16 v[196:211], v[68:71], v[20:23], v[196:211]
    ds_read_b64_tr_b16 v[96:97], v9 offset:14848
    ds_read_b64_tr_b16 v[98:99], v10 offset:14848
    s_waitcnt vmcnt(6)
    s_barrier
    s_waitcnt lgkmcnt(10)
    v_mfma_f32_32x32x16_bf16 v[100:115], v[72:75], v[24:27], v[100:115]
    ds_read_b64_tr_b16 v[44:45], v8 offset:28672
    ds_read_b64_tr_b16 v[46:47], v8 offset:28928
    s_add_u32 m0, s68, 0
    v_mfma_f32_32x32x16_bf16 v[116:131], v[76:79], v[24:27], v[116:131]
    ds_read_b64_tr_b16 v[48:49], v8 offset:30720
    ds_read_b64_tr_b16 v[50:51], v8 offset:30976
    buffer_load_dwordx4 v6, s[48:51], s64 offen offset:0 lds
    s_waitcnt lgkmcnt(10)
    s_add_u32 m0, s68, 4032
    v_mfma_f32_32x32x16_bf16 v[132:147], v[80:83], v[24:27], v[132:147]
    ds_read_b64_tr_b16 v[52:53], v8 offset:32768
    ds_read_b64_tr_b16 v[54:55], v8 offset:33024
    buffer_load_dwordx4 v6, s[48:51], s64 offen offset:64 lds
    s_add_u32 m0, s68, 8064
    v_mfma_f32_32x32x16_bf16 v[148:163], v[84:87], v[24:27], v[148:163]
    ds_read_b64_tr_b16 v[56:57], v8 offset:34816
    ds_read_b64_tr_b16 v[58:59], v8 offset:35072
    buffer_load_dwordx4 v6, s[48:51], s64 offen offset:128 lds
    s_waitcnt lgkmcnt(10)
    s_add_u32 m0, s71, 0
    v_mfma_f32_32x32x16_bf16 v[164:179], v[88:91], v[24:27], v[164:179]
    ds_read_b64_tr_b16 v[60:61], v8 offset:36864
    ds_read_b64_tr_b16 v[62:63], v8 offset:37120
    s_mov_b64 exec, s[14:15]
    buffer_load_dwordx4 v7, s[48:51], s64 offen lds
    s_mov_b64 exec, -1
    s_add_u32 s64, s64, 114688
    v_mfma_f32_32x32x16_bf16 v[180:195], v[92:95], v[24:27], v[180:195]
    ds_read_b64_tr_b16 v[64:65], v8 offset:38912
    ds_read_b64_tr_b16 v[66:67], v8 offset:39168
    buffer_load_dwordx4 v[12:15], v2, s[36:39], s72 offen offset:0 sc1
    s_waitcnt lgkmcnt(12)
    v_mfma_f32_32x32x16_bf16 v[196:211], v[96:99], v[24:27], v[196:211]
    ds_read_b64_tr_b16 v[68:69], v9 offset:28672
    ds_read_b64_tr_b16 v[70:71], v10 offset:28672
    buffer_load_dwordx4 v[16:19], v2, s[36:39], s72 offen offset:1024 sc1
    s_waitcnt lgkmcnt(10)
    v_mfma_f32_32x32x16_bf16 v[100:115], v[44:47], v[28:31], v[100:115]
    ds_read_b64_tr_b16 v[72:73], v8 offset:29696
    ds_read_b64_tr_b16 v[74:75], v8 offset:29952
    v_mfma_f32_32x32x16_bf16 v[116:131], v[48:51], v[28:31], v[116:131]
    ds_read_b64_tr_b16 v[76:77], v8 offset:31744
    ds_read_b64_tr_b16 v[78:79], v8 offset:32000
    s_waitcnt lgkmcnt(10)
    v_mfma_f32_32x32x16_bf16 v[132:147], v[52:55], v[28:31], v[132:147]
    ds_read_b64_tr_b16 v[80:81], v8 offset:33792
    ds_read_b64_tr_b16 v[82:83], v8 offset:34048
    v_mfma_f32_32x32x16_bf16 v[148:163], v[56:59], v[28:31], v[148:163]
    ds_read_b64_tr_b16 v[84:85], v8 offset:35840
    ds_read_b64_tr_b16 v[86:87], v8 offset:36096
    s_waitcnt lgkmcnt(10)
    v_mfma_f32_32x32x16_bf16 v[164:179], v[60:63], v[28:31], v[164:179]
    ds_read_b64_tr_b16 v[88:89], v8 offset:37888
    ds_read_b64_tr_b16 v[90:91], v8 offset:38144
    v_mfma_f32_32x32x16_bf16 v[180:195], v[64:67], v[28:31], v[180:195]
    ds_read_b64_tr_b16 v[92:93], v8 offset:39936
    ds_read_b64_tr_b16 v[94:95], v8 offset:40192
    s_waitcnt lgkmcnt(12)
    v_mfma_f32_32x32x16_bf16 v[196:211], v[68:71], v[28:31], v[196:211]
    ds_read_b64_tr_b16 v[96:97], v9 offset:29184
    ds_read_b64_tr_b16 v[98:99], v10 offset:29184
    s_waitcnt vmcnt(6)
    s_barrier
    s_waitcnt lgkmcnt(10)
    v_mfma_f32_32x32x16_bf16 v[100:115], v[72:75], v[32:35], v[100:115]
    ds_read_b64_tr_b16 v[44:45], v8 offset:43008
    ds_read_b64_tr_b16 v[46:47], v8 offset:43264
    s_add_u32 m0, s68, 14336
    v_mfma_f32_32x32x16_bf16 v[116:131], v[76:79], v[32:35], v[116:131]
    ds_read_b64_tr_b16 v[48:49], v8 offset:45056
    ds_read_b64_tr_b16 v[50:51], v8 offset:45312
    buffer_load_dwordx4 v6, s[48:51], s64 offen offset:0 lds
    s_waitcnt lgkmcnt(10)
    s_add_u32 m0, s68, 18368
    v_mfma_f32_32x32x16_bf16 v[132:147], v[80:83], v[32:35], v[132:147]
    ds_read_b64_tr_b16 v[52:53], v8 offset:47104
    ds_read_b64_tr_b16 v[54:55], v8 offset:47360
    buffer_load_dwordx4 v6, s[48:51], s64 offen offset:64 lds
    s_add_u32 m0, s68, 22400
    v_mfma_f32_32x32x16_bf16 v[148:163], v[84:87], v[32:35], v[148:163]
    ds_read_b64_tr_b16 v[56:57], v8 offset:49152
    ds_read_b64_tr_b16 v[58:59], v8 offset:49408
    buffer_load_dwordx4 v6, s[48:51], s64 offen offset:128 lds
    s_waitcnt lgkmcnt(10)
    s_add_u32 m0, s71, 14336
    v_mfma_f32_32x32x16_bf16 v[164:179], v[88:91], v[32:35], v[164:179]
    ds_read_b64_tr_b16 v[60:61], v8 offset:51200
    ds_read_b64_tr_b16 v[62:63], v8 offset:51456
    s_mov_b64 exec, s[14:15]
    buffer_load_dwordx4 v7, s[48:51], s64 offen lds
    s_mov_b64 exec, -1
    s_add_u32 s64, s64, 114688
    s_sub_u32 s67, s67, 1
    s_cmp_eq_u32 s67, 0
    s_cselect_b32 s10, 1835008, 0
    s_sub_u32 s64, s64, s10
    v_mfma_f32_32x32x16_bf16 v[180:195], v[92:95], v[32:35], v[180:195]
    ds_read_b64_tr_b16 v[64:65], v8 offset:53248
    ds_read_b64_tr_b16 v[66:67], v8 offset:53504
    buffer_load_dwordx4 v[20:23], v2, s[36:39], s72 offen offset:2048 sc1
    s_waitcnt lgkmcnt(12)
    v_mfma_f32_32x32x16_bf16 v[196:211], v[96:99], v[32:35], v[196:211]
    ds_read_b64_tr_b16 v[68:69], v9 offset:43008
    ds_read_b64_tr_b16 v[70:71], v10 offset:43008
    buffer_load_dwordx4 v[24:27], v2, s[36:39], s72 offen offset:3072 sc1
    s_add_u32 s73, s73, 4096
    s_and_b32 s73, s73, 32767
    s_add_u32 s72, s70, s73
    s_waitcnt lgkmcnt(10)
    v_mfma_f32_32x32x16_bf16 v[100:115], v[44:47], v[36:39], v[100:115]
    ds_read_b64_tr_b16 v[72:73], v8 offset:44032
    ds_read_b64_tr_b16 v[74:75], v8 offset:44288
    v_mfma_f32_32x32x16_bf16 v[116:131], v[48:51], v[36:39], v[116:131]
    ds_read_b64_tr_b16 v[76:77], v8 offset:46080
    ds_read_b64_tr_b16 v[78:79], v8 offset:46336
    s_waitcnt lgkmcnt(10)
    v_mfma_f32_32x32x16_bf16 v[132:147], v[52:55], v[36:39], v[132:147]
    ds_read_b64_tr_b16 v[80:81], v8 offset:48128
    ds_read_b64_tr_b16 v[82:83], v8 offset:48384
    v_mfma_f32_32x32x16_bf16 v[148:163], v[56:59], v[36:39], v[148:163]
    ds_read_b64_tr_b16 v[84:85], v8 offset:50176
    ds_read_b64_tr_b16 v[86:87], v8 offset:50432
    s_waitcnt lgkmcnt(10)
    v_mfma_f32_32x32x16_bf16 v[164:179], v[60:63], v[36:39], v[164:179]
    ds_read_b64_tr_b16 v[88:89], v8 offset:52224
    ds_read_b64_tr_b16 v[90:91], v8 offset:52480
    v_mfma_f32_32x32x16_bf16 v[180:195], v[64:67], v[36:39], v[180:195]
    ds_read_b64_tr_b16 v[92:93], v8 offset:54272
    ds_read_b64_tr_b16 v[94:95], v8 offset:54528
    s_waitcnt lgkmcnt(12)
    v_mfma_f32_32x32x16_bf16 v[196:211], v[68:71], v[36:39], v[196:211]
    ds_read_b64_tr_b16 v[96:97], v9 offset:43520
    ds_read_b64_tr_b16 v[98:99], v10 offset:43520
    s_waitcnt vmcnt(6)
    s_barrier
    s_waitcnt lgkmcnt(10)
    v_mfma_f32_32x32x16_bf16 v[100:115], v[72:75], v[40:43], v[100:115]
    ds_read_b64_tr_b16 v[44:45], v8 offset:0
    ds_read_b64_tr_b16 v[46:47], v8 offset:256
    s_add_u32 m0, s68, 28672
    v_mfma_f32_32x32x16_bf16 v[116:131], v[76:79], v[40:43], v[116:131]
    ds_read_b64_tr_b16 v[48:49], v8 offset:2048
    ds_read_b64_tr_b16 v[50:51], v8 offset:2304
    buffer_load_dwordx4 v6, s[48:51], s64 offen offset:0 lds
    s_waitcnt lgkmcnt(10)
    s_add_u32 m0, s68, 32704
    v_mfma_f32_32x32x16_bf16 v[132:147], v[80:83], v[40:43], v[132:147]
    ds_read_b64_tr_b16 v[52:53], v8 offset:4096
    ds_read_b64_tr_b16 v[54:55], v8 offset:4352
    buffer_load_dwordx4 v6, s[48:51], s64 offen offset:64 lds
    s_add_u32 m0, s68, 36736
    v_mfma_f32_32x32x16_bf16 v[148:163], v[84:87], v[40:43], v[148:163]
    ds_read_b64_tr_b16 v[56:57], v8 offset:6144
    ds_read_b64_tr_b16 v[58:59], v8 offset:6400
    buffer_load_dwordx4 v6, s[48:51], s64 offen offset:128 lds
    s_waitcnt lgkmcnt(10)
    s_add_u32 m0, s71, 28672
    v_mfma_f32_32x32x16_bf16 v[164:179], v[88:91], v[40:43], v[164:179]
    ds_read_b64_tr_b16 v[60:61], v8 offset:8192
    ds_read_b64_tr_b16 v[62:63], v8 offset:8448
    s_mov_b64 exec, s[14:15]
    buffer_load_dwordx4 v7, s[48:51], s64 offen lds
    s_mov_b64 exec, -1
    s_add_u32 s64, s64, 114688
    v_mfma_f32_32x32x16_bf16 v[180:195], v[92:95], v[40:43], v[180:195]
    ds_read_b64_tr_b16 v[64:65], v8 offset:10240
    ds_read_b64_tr_b16 v[66:67], v8 offset:10496
    buffer_load_dwordx4 v[28:31], v2, s[36:39], s72 offen offset:0 sc1
    s_waitcnt lgkmcnt(12)
    v_mfma_f32_32x32x16_bf16 v[196:211], v[96:99], v[40:43], v[196:211]
    ds_read_b64_tr_b16 v[68:69], v9 offset:0
    ds_read_b64_tr_b16 v[70:71], v10 offset:0
    buffer_load_dwordx4 v[32:35], v2, s[36:39], s72 offen offset:1024 sc1
    s_sub_u32 s75, s75, 1
    s_cmp_lg_u32 s75, 0
    s_cbranch_scc1 g1B_loop
    s_waitcnt lgkmcnt(10)
    v_mfma_f32_32x32x16_bf16 v[100:115], v[44:47], v[12:15], v[100:115]
    ds_read_b64_tr_b16 v[72:73], v8 offset:1024
    ds_read_b64_tr_b16 v[74:75], v8 offset:1280
    v_mfma_f32_32x32x16_bf16 v[116:131], v[48:51], v[12:15], v[116:131]
    ds_read_b64_tr_b16 v[76:77], v8 offset:3072
    ds_read_b64_tr_b16 v[78:79], v8 offset:3328
    s_waitcnt lgkmcnt(10)
    v_mfma_f32_32x32x16_bf16 v[132:147], v[52:55], v[12:15], v[132:147]
    ds_read_b64_tr_b16 v[80:81], v8 offset:5120
    ds_read_b64_tr_b16 v[82:83], v8 offset:5376
    v_mfma_f32_32x32x16_bf16 v[148:163], v[56:59], v[12:15], v[148:163]
    ds_read_b64_tr_b16 v[84:85], v8 offset:7168
    ds_read_b64_tr_b16 v[86:87], v8 offset:7424
    s_waitcnt lgkmcnt(10)
    v_mfma_f32_32x32x16_bf16 v[164:179], v[60:63], v[12:15], v[164:179]
    ds_read_b64_tr_b16 v[88:89], v8 offset:9216
    ds_read_b64_tr_b16 v[90:91], v8 offset:9472
    v_mfma_f32_32x32x16_bf16 v[180:195], v[64:67], v[12:15], v[180:195]
    ds_read_b64_tr_b16 v[92:93], v8 offset:11264
    ds_read_b64_tr_b16 v[94:95], v8 offset:11520
    s_waitcnt lgkmcnt(12)
    v_mfma_f32_32x32x16_bf16 v[196:211], v[68:71], v[12:15], v[196:211]
    ds_read_b64_tr_b16 v[96:97], v9 offset:512
    ds_read_b64_tr_b16 v[98:99], v10 offset:512
    s_waitcnt vmcnt(6)
    s_barrier
    s_waitcnt lgkmcnt(10)
    v_mfma_f32_32x32x16_bf16 v[100:115], v[72:75], v[16:19], v[100:115]
    ds_read_b64_tr_b16 v[44:45], v8 offset:14336
    ds_read_b64_tr_b16 v[46:47], v8 offset:14592
    s_add_u32 m0, s68, 43008
    v_mfma_f32_32x32x16_bf16 v[116:131], v[76:79], v[16:19], v[116:131]
    ds_read_b64_tr_b16 v[48:49], v8 offset:16384
    ds_read_b64_tr_b16 v[50:51], v8 offset:16640
    buffer_load_dwordx4 v6, s[48:51], s64 offen offset:0 lds
    s_waitcnt lgkmcnt(10)
    s_add_u32 m0, s68, 47040
    v_mfma_f32_32x32x16_bf16 v[132:147], v[80:83], v[16:19], v[132:147]
    ds_read_b64_tr_b16 v[52:53], v8 offset:18432
    ds_read_b64_tr_b16 v[54:55], v8 offset:18688
    buffer_load_dwordx4 v6, s[48:51], s64 offen offset:64 lds
    s_add_u32 m0, s68, 51072
    v_mfma_f32_32x32x16_bf16 v[148:163], v[84:87], v[16:19], v[148:163]
    ds_read_b64_tr_b16 v[56:57], v8 offset:20480
    ds_read_b64_tr_b16 v[58:59], v8 offset:20736
    buffer_load_dwordx4 v6, s[48:51], s64 offen offset:128 lds
    s_waitcnt lgkmcnt(10)
    s_add_u32 m0, s71, 43008
    v_mfma_f32_32x32x16_bf16 v[164:179], v[88:91], v[16:19], v[164:179]
    ds_read_b64_tr_b16 v[60:61], v8 offset:22528
    ds_read_b64_tr_b16 v[62:63], v8 offset:22784
    s_mov_b64 exec, s[14:15]
    buffer_load_dwordx4 v7, s[48:51], s64 offen lds
    s_mov_b64 exec, -1
    s_add_u32 s64, s64, 114688
    s_sub_u32 s67, s67, 1
    s_cmp_eq_u32 s67, 0
    s_cselect_b32 s10, 1835008, 0
    s_sub_u32 s64, s64, s10
    v_mfma_f32_32x32x16_bf16 v[180:195], v[92:95], v[16:19], v[180:195]
    ds_read_b64_tr_b16 v[64:65], v8 offset:24576
    ds_read_b64_tr_b16 v[66:67], v8 offset:24832
    buffer_load_dwordx4 v[36:39], v2, s[36:39], s72 offen offset:2048 sc1
    s_waitcnt lgkmcnt(12)
    v_mfma_f32_32x32x16_bf16 v[196:211], v[96:99], v[16:19], v[196:211]
    ds_read_b64_tr_b16 v[68:69], v9 offset:14336
    ds_read_b64_tr_b16 v[70:71], v10 offset:14336
    buffer_load_dwordx4 v[40:43], v2, s[36:39], s72 offen offset:3072 sc1
    s_add_u32 s73, s73, 4096
    s_and_b32 s73, s73, 32767
    s_add_u32 s72, s70, s73
    s_waitcnt lgkmcnt(10)
    v_mfma_f32_32x32x16_bf16 v[100:115], v[44:47], v[20:23], v[100:115]
    ds_read_b64_tr_b16 v[72:73], v8 offset:15360
    ds_read_b64_tr_b16 v[74:75], v8 offset:15616
    v_mfma_f32_32x32x16_bf16 v[116:131], v[48:51], v[20:23], v[116:131]
    ds_read_b64_tr_b16 v[76:77], v8 offset:17408
    ds_read_b64_tr_b16 v[78:79], v8 offset:17664
    s_waitcnt lgkmcnt(10)
    v_mfma_f32_32x32x16_bf16 v[132:147], v[52:55], v[20:23], v[132:147]
    ds_read_b64_tr_b16 v[80:81], v8 offset:19456
    ds_read_b64_tr_b16 v[82:83], v8 offset:19712
    v_mfma_f32_32x32x16_bf16 v[148:163], v[56:59], v[20:23], v[148:163]
    ds_read_b64_tr_b16 v[84:85], v8 offset:21504
    ds_read_b64_tr_b16 v[86:87], v8 offset:21760
    s_waitcnt lgkmcnt(10)
    v_mfma_f32_32x32x16_bf16 v[164:179], v[60:63], v[20:23], v[164:179]
    ds_read_b64_tr_b16 v[88:89], v8 offset:23552
    ds_read_b64_tr_b16 v[90:91], v8 offset:23808
    v_mfma_f32_32x32x16_bf16 v[180:195], v[64:67], v[20:23], v[180:195]
    ds_read_b64_tr_b16 v[92:93], v8 offset:25600
    ds_read_b64_tr_b16 v[94:95], v8 offset:25856
    s_waitcnt lgkmcnt(12)
    v_mfma_f32_32x32x16_bf16 v[196:211], v[68:71], v[20:23], v[196:211]
    ds_read_b64_tr_b16 v[96:97], v9 offset:14848
    ds_read_b64_tr_b16 v[98:99], v10 offset:14848
    s_waitcnt vmcnt(6)
    s_barrier
    s_waitcnt lgkmcnt(10)
    v_mfma_f32_32x32x16_bf16 v[100:115], v[72:75], v[24:27], v[100:115]
    ds_read_b64_tr_b16 v[44:45], v8 offset:28672
    ds_read_b64_tr_b16 v[46:47], v8 offset:28928
    v_mfma_f32_32x32x16_bf16 v[116:131], v[76:79], v[24:27], v[116:131]
    ds_read_b64_tr_b16 v[48:49], v8 offset:30720
    ds_read_b64_tr_b16 v[50:51], v8 offset:30976
    s_waitcnt lgkmcnt(10)
    v_mfma_f32_32x32x16_bf16 v[132:147], v[80:83], v[24:27], v[132:147]
    ds_read_b64_tr_b16 v[52:53], v8 offset:32768
    ds_read_b64_tr_b16 v[54:55], v8 offset:33024
    v_mfma_f32_32x32x16_bf16 v[148:163], v[84:87], v[24:27], v[148:163]
    ds_read_b64_tr_b16 v[56:57], v8 offset:34816
    ds_read_b64_tr_b16 v[58:59], v8 offset:35072
    s_waitcnt lgkmcnt(10)
    v_mfma_f32_32x32x16_bf16 v[164:179], v[88:91], v[24:27], v[164:179]
    ds_read_b64_tr_b16 v[60:61], v8 offset:36864
    ds_read_b64_tr_b16 v[62:63], v8 offset:37120
    v_mfma_f32_32x32x16_bf16 v[180:195], v[92:95], v[24:27], v[180:195]
    ds_read_b64_tr_b16 v[64:65], v8 offset:38912
    ds_read_b64_tr_b16 v[66:67], v8 offset:39168
    s_waitcnt lgkmcnt(12)
    v_mfma_f32_32x32x16_bf16 v[196:211], v[96:99], v[24:27], v[196:211]
    ds_read_b64_tr_b16 v[68:69], v9 offset:28672
    ds_read_b64_tr_b16 v[70:71], v10 offset:28672
    s_waitcnt lgkmcnt(10)
    v_mfma_f32_32x32x16_bf16 v[100:115], v[44:47], v[28:31], v[100:115]
    ds_read_b64_tr_b16 v[72:73], v8 offset:29696
    ds_read_b64_tr_b16 v[74:75], v8 offset:29952
    v_mfma_f32_32x32x16_bf16 v[116:131], v[48:51], v[28:31], v[116:131]
    ds_read_b64_tr_b16 v[76:77], v8 offset:31744
    ds_read_b64_tr_b16 v[78:79], v8 offset:32000
    s_waitcnt lgkmcnt(10)
    v_mfma_f32_32x32x16_bf16 v[132:147], v[52:55], v[28:31], v[132:147]
    ds_read_b64_tr_b16 v[80:81], v8 offset:33792
    ds_read_b64_tr_b16 v[82:83], v8 offset:34048
    v_mfma_f32_32x32x16_bf16 v[148:163], v[56:59], v[28:31], v[148:163]
    ds_read_b64_tr_b16 v[84:85], v8 offset:35840
    ds_read_b64_tr_b16 v[86:87], v8 offset:36096
    s_waitcnt lgkmcnt(10)
    v_mfma_f32_32x32x16_bf16 v[164:179], v[60:63], v[28:31], v[164:179]
    ds_read_b64_tr_b16 v[88:89], v8 offset:37888
    ds_read_b64_tr_b16 v[90:91], v8 offset:38144
    v_mfma_f32_32x32x16_bf16 v[180:195], v[64:67], v[28:31], v[180:195]
    ds_read_b64_tr_b16 v[92:93], v8 offset:39936
    ds_read_b64_tr_b16 v[94:95], v8 offset:40192
    s_waitcnt lgkmcnt(12)
    v_mfma_f32_32x32x16_bf16 v[196:211], v[68:71], v[28:31], v[196:211]
    ds_read_b64_tr_b16 v[96:97], v9 offset:29184
    ds_read_b64_tr_b16 v[98:99], v10 offset:29184
    s_waitcnt vmcnt(0)
    s_barrier
    s_waitcnt lgkmcnt(10)
    v_mfma_f32_32x32x16_bf16 v[100:115], v[72:75], v[32:35], v[100:115]
    ds_read_b64_tr_b16 v[44:45], v8 offset:43008
    ds_read_b64_tr_b16 v[46:47], v8 offset:43264
    v_mfma_f32_32x32x16_bf16 v[116:131], v[76:79], v[32:35], v[116:131]
    ds_read_b64_tr_b16 v[48:49], v8 offset:45056
    ds_read_b64_tr_b16 v[50:51], v8 offset:45312
    s_waitcnt lgkmcnt(10)
    v_mfma_f32_32x32x16_bf16 v[132:147], v[80:83], v[32:35], v[132:147]
    ds_read_b64_tr_b16 v[52:53], v8 offset:47104
    ds_read_b64_tr_b16 v[54:55], v8 offset:47360
    v_mfma_f32_32x32x16_bf16 v[148:163], v[84:87], v[32:35], v[148:163]
    ds_read_b64_tr_b16 v[56:57], v8 offset:49152
    ds_read_b64_tr_b16 v[58:59], v8 offset:49408
    s_waitcnt lgkmcnt(10)
    v_mfma_f32_32x32x16_bf16 v[164:179], v[88:91], v[32:35], v[164:179]
    ds_read_b64_tr_b16 v[60:61], v8 offset:51200
    ds_read_b64_tr_b16 v[62:63], v8 offset:51456
    v_mfma_f32_32x32x16_bf16 v[180:195], v[92:95], v[32:35], v[180:195]
    ds_read_b64_tr_b16 v[64:65], v8 offset:53248
    ds_read_b64_tr_b16 v[66:67], v8 offset:53504
    s_waitcnt lgkmcnt(12)
    v_mfma_f32_32x32x16_bf16 v[196:211], v[96:99], v[32:35], v[196:211]
    ds_read_b64_tr_b16 v[68:69], v9 offset:43008
    ds_read_b64_tr_b16 v[70:71], v10 offset:43008
    s_waitcnt lgkmcnt(10)
    v_mfma_f32_32x32x16_bf16 v[100:115], v[44:47], v[36:39], v[100:115]
    ds_read_b64_tr_b16 v[72:73], v8 offset:44032
    ds_read_b64_tr_b16 v[74:75], v8 offset:44288
    v_mfma_f32_32x32x16_bf16 v[116:131], v[48:51], v[36:39], v[116:131]
    ds_read_b64_tr_b16 v[76:77], v8 offset:46080
    ds_read_b64_tr_b16 v[78:79], v8 offset:46336
    s_waitcnt lgkmcnt(10)
    v_mfma_f32_32x32x16_bf16 v[132:147], v[52:55], v[36:39], v[132:147]
    ds_read_b64_tr_b16 v[80:81], v8 offset:48128
    ds_read_b64_tr_b16 v[82:83], v8 offset:48384
    v_mfma_f32_32x32x16_bf16 v[148:163], v[56:59], v[36:39], v[148:163]
    ds_read_b64_tr_b16 v[84:85], v8 offset:50176
    ds_read_b64_tr_b16 v[86:87], v8 offset:50432
    s_waitcnt lgkmcnt(10)
    v_mfma_f32_32x32x16_bf16 v[164:179], v[60:63], v[36:39], v[164:179]
    ds_read_b64_tr_b16 v[88:89], v8 offset:52224
    ds_read_b64_tr_b16 v[90:91], v8 offset:52480
    v_mfma_f32_32x32x16_bf16 v[180:195], v[64:67], v[36:39], v[180:195]
    ds_read_b64_tr_b16 v[92:93], v8 offset:54272
    ds_read_b64_tr_b16 v[94:95], v8 offset:54528
    s_waitcnt lgkmcnt(12)
    v_mfma_f32_32x32x16_bf16 v[196:211], v[68:71], v[36:39], v[196:211]
    ds_read_b64_tr_b16 v[96:97], v9 offset:43520
    ds_read_b64_tr_b16 v[98:99], v10 offset:43520
    s_waitcnt lgkmcnt(10)
    v_mfma_f32_32x32x16_bf16 v[100:115], v[72:75], v[40:43], v[100:115]
    v_mfma_f32_32x32x16_bf16 v[116:131], v[76:79], v[40:43], v[116:131]
    s_waitcnt lgkmcnt(6)
    v_mfma_f32_32x32x16_bf16 v[132:147], v[80:83], v[40:43], v[132:147]
    v_mfma_f32_32x32x16_bf16 v[148:163], v[84:87], v[40:43], v[148:163]
    s_waitcnt lgkmcnt(2)
    v_mfma_f32_32x32x16_bf16 v[164:179], v[88:91], v[40:43], v[164:179]
    v_mfma_f32_32x32x16_bf16 v[180:195], v[92:95], v[40:43], v[180:195]
    s_waitcnt lgkmcnt(0)
    v_mfma_f32_32x32x16_bf16 v[196:211], v[96:99], v[40:43], v[196:211]
    s_barrier
    s_and_b32 s3, s2, 7
    s_bfe_u32 s4, s2, 0x50003
    s_lshl_b32 s5, s3, 2
    s_and_b32 s6, s4, 3
    s_add_u32 s12, s5, s6
    s_lshr_b32 s13, s4, 2
    s_mov_b32 s44, s20
    s_mov_b32 s45, s21
    s_mov_b32 s46, 524288
    s_mov_b32 s47, 0x00020000
    s_mov_b32 s48, s28
    s_mov_b32 s49, s29
    s_mov_b32 s50, 1835008
    s_mov_b32 s51, 0x00020000
    s_mul_i32 s53, s40, 458752
    s_lshl_b32 s52, s40, 17
    s_mul_i32 s54, s12, 288
    s_mul_i32 s5, s40, 28
    s_add_u32 s5, s5, s54
    s_add_u32 s5, s5, 32
    s_lshl_b32 s5, s5, 10
    s_add_u32 s60, s5, 8388608
    s_add_u32 s61, s60, 147456
    s_lshl_b32 s5, s40, 3
    s_add_u32 s5, s5, s54
    s_lshl_b32 s5, s5, 10
    s_add_u32 s62, s5, 8388608
    s_add_u32 s63, s62, 147456
    s_mul_i32 s56, s40, 16384
    s_and_b32 s5, s12, 3
    s_lshl_b32 s5, s5, 1
    s_add_u32 s5, s5, s13
    s_cmp_ge_u32 s5, 7
    s_cselect_b32 s6, 7, 0
    s_sub_u32 s5, s5, s6
    s_lshl_b32 s6, s5, 16
    s_add_u32 s53, s53, s6
    s_lshl_b32 s6, s5, 12
    s_add_u32 s60, s60, s6
    s_add_u32 s61, s61, s6
    s_sub_u32 s64, 7, s5
    s_mov_b32 s65, s64
    v_lshlrev_b32 v2, 4, v1
    v_lshrrev_b32 v3, 5, v1
    v_lshlrev_b32 v4, 2, v3
    v_bfe_u32 v5, v1, 2, 2
    v_add_u32 v4, v4, v5
    v_lshlrev_b32 v4, 10, v4
    v_bfe_u32 v6, v1, 4, 1
    v_lshl_add_u32 v4, v6, 6, v4
    v_and_b32 v7, 3, v1
    v_lshl_add_u32 v4, v7, 4, v4
    s_lshl_b32 s57, s13, 7
    v_add_u32 v4, s57, v4
    v_add_u32 v9, 8192, v4
    v_lshlrev_b32 v8, 9, v3
    v_lshl_add_u32 v8, v5, 6, v8
    v_lshl_add_u32 v8, v6, 5, v8
    v_lshl_add_u32 v8, v7, 3, v8
    v_add_u32 v8, s56, v8
    s_add_u32 m0, s56, 0
    s_nop 0
    buffer_load_dwordx4 v4, s[48:51], s53 offen lds
    s_add_u32 m0, s56, 1024
    s_nop 0
    buffer_load_dwordx4 v9, s[48:51], s53 offen lds
    s_add_u32 s53, s53, 16384
    s_add_u32 m0, s56, 2048
    s_nop 0
    buffer_load_dwordx4 v4, s[48:51], s53 offen lds
    s_add_u32 m0, s56, 3072
    s_nop 0
    buffer_load_dwordx4 v9, s[48:51], s53 offen lds
    s_add_u32 s53, s53, 16384
    s_add_u32 m0, s56, 4096
    s_nop 0
    buffer_load_dwordx4 v4, s[48:51], s53 offen lds
    s_add_u32 m0, s56, 5120
    s_nop 0
    buffer_load_dwordx4 v9, s[48:51], s53 offen lds
    s_add_u32 s53, s53, 16384
    s_add_u32 m0, s56, 6144
    s_nop 0
    buffer_load_dwordx4 v4, s[48:51], s53 offen lds
    s_add_u32 m0, s56, 7168
    s_nop 0
    buffer_load_dwordx4 v9, s[48:51], s53 offen lds
    s_add_u32 s53, s53, 16384
    s_sub_u32 s64, s64, 1
    s_cmp_eq_u32 s64, 0
    s_cselect_b32 s6, 458752, 0
    s_sub_u32 s53, s53, s6
    s_add_u32 m0, s56, 8192
    s_nop 0
    buffer_load_dwordx4 v4, s[48:51], s53 offen lds
    s_add_u32 m0, s56, 9216
    s_nop 0
    buffer_load_dwordx4 v9, s[48:51], s53 offen lds
    s_add_u32 s53, s53, 16384
    s_add_u32 m0, s56, 10240
    s_nop 0
    buffer_load_dwordx4 v4, s[48:51], s53 offen lds
    s_add_u32 m0, s56, 11264
    s_nop 0
    buffer_load_dwordx4 v9, s[48:51], s53 offen lds
    s_add_u32 s53, s53, 16384
    s_add_u32 m0, s56, 12288
    s_nop 0
    buffer_load_dwordx4 v4, s[48:51], s53 offen lds
    s_add_u32 m0, s56, 13312
    s_nop 0
    buffer_load_dwordx4 v9, s[48:51], s53 offen lds
    s_add_u32 s53, s53, 16384
    s_add_u32 m0, s56, 14336
    s_nop 0
    buffer_load_dwordx4 v4, s[48:51], s53 offen lds
    s_add_u32 m0, s56, 15360
    s_nop 0
    buffer_load_dwordx4 v9, s[48:51], s53 offen lds
    s_add_u32 s53, s53, 16384
    s_sub_u32 s64, s64, 1
    s_cmp_eq_u32 s64, 0
    s_cselect_b32 s6, 458752, 0
    s_sub_u32 s53, s53, s6
    v_lshlrev_b32 v2, 4, v1
    s_mul_i32 s3, s43, 144
    s_mul_i32 s4, s42, 7
    s_add_u32 s3, s3, s4
    s_add_u32 s3, s3, 32
    s_and_b32 s7, s42, 1
    s_add_u32 s4, s3, s7
    s_cmp_eq_u32 s7, 0
    s_cselect_b32 s5, 6, 0
    s_add_u32 s5, s3, s5
    s_lshl_b32 s4, s4, 10
    s_add_u32 s4, s4, 8388608
    s_lshl_b32 s5, s5, 10
    s_add_u32 s5, s5, 8388608
    s_add_u32 s6, s4, 4096
    s_mov_b32 s9, 0xbfb8aa3b
    s_mov_b32 s8, s9
    s_mov_b32 s10, 1.0
    s_mov_b32 s11, 1.0
    v_pk_mul_f32 v[212:213], v[100:101], s[8:9]
    v_pk_mul_f32 v[214:215], v[102:103], s[8:9]
    v_pk_mul_f32 v[216:217], v[104:105], s[8:9]
    v_pk_mul_f32 v[218:219], v[106:107], s[8:9]
    v_pk_mul_f32 v[220:221], v[108:109], s[8:9]
    v_pk_mul_f32 v[222:223], v[110:111], s[8:9]
    v_pk_mul_f32 v[224:225], v[112:113], s[8:9]
    v_pk_mul_f32 v[226:227], v[114:115], s[8:9]
    v_exp_f32 v212, v212
    v_exp_f32 v213, v213
    v_exp_f32 v214, v214
    v_exp_f32 v215, v215
    v_exp_f32 v216, v216
    v_exp_f32 v217, v217
    v_exp_f32 v218, v218
    v_exp_f32 v219, v219
    v_exp_f32 v220, v220
    v_exp_f32 v221, v221
    v_exp_f32 v222, v222
    v_exp_f32 v223, v223
    v_exp_f32 v224, v224
    v_exp_f32 v225, v225
    v_exp_f32 v226, v226
    v_exp_f32 v227, v227
    v_pk_mul_f32 v[100:101], v[100:101], v[116:117]
    v_pk_mul_f32 v[102:103], v[102:103], v[118:119]
    v_pk_mul_f32 v[104:105], v[104:105], v[120:121]
    v_pk_mul_f32 v[106:107], v[106:107], v[122:123]
    v_pk_mul_f32 v[108:109], v[108:109], v[124:125]
    v_pk_mul_f32 v[110:111], v[110:111], v[126:127]
    v_pk_mul_f32 v[112:113], v[112:113], v[128:129]
    v_pk_mul_f32 v[114:115], v[114:115], v[130:131]
    v_pk_add_f32 v[212:213], v[212:213], s[10:11]
    v_pk_add_f32 v[214:215], v[214:215], s[10:11]
    v_pk_add_f32 v[216:217], v[216:217], s[10:11]
    v_pk_add_f32 v[218:219], v[218:219], s[10:11]
    v_pk_add_f32 v[220:221], v[220:221], s[10:11]
    v_pk_add_f32 v[222:223], v[222:223], s[10:11]
    v_pk_add_f32 v[224:225], v[224:225], s[10:11]
    v_pk_add_f32 v[226:227], v[226:227], s[10:11]
    v_rcp_f32 v212, v212
    v_rcp_f32 v213, v213
    v_rcp_f32 v214, v214
    v_rcp_f32 v215, v215
    v_rcp_f32 v216, v216
    v_rcp_f32 v217, v217
    v_rcp_f32 v218, v218
    v_rcp_f32 v219, v219
    v_rcp_f32 v220, v220
    v_rcp_f32 v221, v221
    v_rcp_f32 v222, v222
    v_rcp_f32 v223, v223
    v_rcp_f32 v224, v224
    v_rcp_f32 v225, v225
    v_rcp_f32 v226, v226
    v_rcp_f32 v227, v227
    s_nop 0
    v_pk_mul_f32 v[100:101], v[100:101], v[212:213]
    v_pk_mul_f32 v[102:103], v[102:103], v[214:215]
    v_pk_mul_f32 v[104:105], v[104:105], v[216:217]
    v_pk_mul_f32 v[106:107], v[106:107], v[218:219]
    v_pk_mul_f32 v[108:109], v[108:109], v[220:221]
    v_pk_mul_f32 v[110:111], v[110:111], v[222:223]
    v_pk_mul_f32 v[112:113], v[112:113], v[224:225]
    v_pk_mul_f32 v[114:115], v[114:115], v[226:227]
    v_cvt_pk_bf16_f32 v44, v100, v101
    v_cvt_pk_bf16_f32 v45, v102, v103
    v_cvt_pk_bf16_f32 v46, v104, v105
    v_cvt_pk_bf16_f32 v47, v106, v107
    v_cvt_pk_bf16_f32 v48, v108, v109
    v_cvt_pk_bf16_f32 v49, v110, v111
    v_cvt_pk_bf16_f32 v50, v112, v113
    v_cvt_pk_bf16_f32 v51, v114, v115
    buffer_store_dwordx4 v[44:47], v2, s[36:39], s4 offen offset:0 sc1
    buffer_store_dwordx4 v[48:51], v2, s[36:39], s4 offen offset:1024 sc1
    v_pk_mul_f32 v[212:213], v[132:133], s[8:9]
    v_pk_mul_f32 v[214:215], v[134:135], s[8:9]
    v_pk_mul_f32 v[216:217], v[136:137], s[8:9]
    v_pk_mul_f32 v[218:219], v[138:139], s[8:9]
    v_pk_mul_f32 v[220:221], v[140:141], s[8:9]
    v_pk_mul_f32 v[222:223], v[142:143], s[8:9]
    v_pk_mul_f32 v[224:225], v[144:145], s[8:9]
    v_pk_mul_f32 v[226:227], v[146:147], s[8:9]
    v_exp_f32 v212, v212
    v_exp_f32 v213, v213
    v_exp_f32 v214, v214
    v_exp_f32 v215, v215
    v_exp_f32 v216, v216
    v_exp_f32 v217, v217
    v_exp_f32 v218, v218
    v_exp_f32 v219, v219
    v_exp_f32 v220, v220
    v_exp_f32 v221, v221
    v_exp_f32 v222, v222
    v_exp_f32 v223, v223
    v_exp_f32 v224, v224
    v_exp_f32 v225, v225
    v_exp_f32 v226, v226
    v_exp_f32 v227, v227
    v_pk_mul_f32 v[132:133], v[132:133], v[148:149]
    v_pk_mul_f32 v[134:135], v[134:135], v[150:151]
    v_pk_mul_f32 v[136:137], v[136:137], v[152:153]
    v_pk_mul_f32 v[138:139], v[138:139], v[154:155]
    v_pk_mul_f32 v[140:141], v[140:141], v[156:157]
    v_pk_mul_f32 v[142:143], v[142:143], v[158:159]
    v_pk_mul_f32 v[144:145], v[144:145], v[160:161]
    v_pk_mul_f32 v[146:147], v[146:147], v[162:163]
    v_pk_add_f32 v[212:213], v[212:213], s[10:11]
    v_pk_add_f32 v[214:215], v[214:215], s[10:11]
    v_pk_add_f32 v[216:217], v[216:217], s[10:11]
    v_pk_add_f32 v[218:219], v[218:219], s[10:11]
    v_pk_add_f32 v[220:221], v[220:221], s[10:11]
    v_pk_add_f32 v[222:223], v[222:223], s[10:11]
    v_pk_add_f32 v[224:225], v[224:225], s[10:11]
    v_pk_add_f32 v[226:227], v[226:227], s[10:11]
    v_rcp_f32 v212, v212
    v_rcp_f32 v213, v213
    v_rcp_f32 v214, v214
    v_rcp_f32 v215, v215
    v_rcp_f32 v216, v216
    v_rcp_f32 v217, v217
    v_rcp_f32 v218, v218
    v_rcp_f32 v219, v219
    v_rcp_f32 v220, v220
    v_rcp_f32 v221, v221
    v_rcp_f32 v222, v222
    v_rcp_f32 v223, v223
    v_rcp_f32 v224, v224
    v_rcp_f32 v225, v225
    v_rcp_f32 v226, v226
    v_rcp_f32 v227, v227
    s_nop 0
    v_pk_mul_f32 v[132:133], v[132:133], v[212:213]
    v_pk_mul_f32 v[134:135], v[134:135], v[214:215]
    v_pk_mul_f32 v[136:137], v[136:137], v[216:217]
    v_pk_mul_f32 v[138:139], v[138:139], v[218:219]
    v_pk_mul_f32 v[140:141], v[140:141], v[220:221]
    v_pk_mul_f32 v[142:143], v[142:143], v[222:223]
    v_pk_mul_f32 v[144:145], v[144:145], v[224:225]
    v_pk_mul_f32 v[146:147], v[146:147], v[226:227]
    v_cvt_pk_bf16_f32 v52, v132, v133
    v_cvt_pk_bf16_f32 v53, v134, v135
    v_cvt_pk_bf16_f32 v54, v136, v137
    v_cvt_pk_bf16_f32 v55, v138, v139
    v_cvt_pk_bf16_f32 v56, v140, v141
    v_cvt_pk_bf16_f32 v57, v142, v143
    v_cvt_pk_bf16_f32 v58, v144, v145
    v_cvt_pk_bf16_f32 v59, v146, v147
    buffer_store_dwordx4 v[52:55], v2, s[36:39], s4 offen offset:2048 sc1
    buffer_store_dwordx4 v[56:59], v2, s[36:39], s4 offen offset:3072 sc1
    v_pk_mul_f32 v[212:213], v[164:165], s[8:9]
    v_pk_mul_f32 v[214:215], v[166:167], s[8:9]
    v_pk_mul_f32 v[216:217], v[168:169], s[8:9]
    v_pk_mul_f32 v[218:219], v[170:171], s[8:9]
    v_pk_mul_f32 v[220:221], v[172:173], s[8:9]
    v_pk_mul_f32 v[222:223], v[174:175], s[8:9]
    v_pk_mul_f32 v[224:225], v[176:177], s[8:9]
    v_pk_mul_f32 v[226:227], v[178:179], s[8:9]
    v_exp_f32 v212, v212
    v_exp_f32 v213, v213
    v_exp_f32 v214, v214
    v_exp_f32 v215, v215
    v_exp_f32 v216, v216
    v_exp_f32 v217, v217
    v_exp_f32 v218, v218
    v_exp_f32 v219, v219
    v_exp_f32 v220, v220
    v_exp_f32 v221, v221
    v_exp_f32 v222, v222
    v_exp_f32 v223, v223
    v_exp_f32 v224, v224
    v_exp_f32 v225, v225
    v_exp_f32 v226, v226
    v_exp_f32 v227, v227
    v_pk_mul_f32 v[164:165], v[164:165], v[180:181]
    v_pk_mul_f32 v[166:167], v[166:167], v[182:183]
    v_pk_mul_f32 v[168:169], v[168:169], v[184:185]
    v_pk_mul_f32 v[170:171], v[170:171], v[186:187]
    v_pk_mul_f32 v[172:173], v[172:173], v[188:189]
    v_pk_mul_f32 v[174:175], v[174:175], v[190:191]
    v_pk_mul_f32 v[176:177], v[176:177], v[192:193]
    v_pk_mul_f32 v[178:179], v[178:179], v[194:195]
    v_pk_add_f32 v[212:213], v[212:213], s[10:11]
    v_pk_add_f32 v[214:215], v[214:215], s[10:11]
    v_pk_add_f32 v[216:217], v[216:217], s[10:11]
    v_pk_add_f32 v[218:219], v[218:219], s[10:11]
    v_pk_add_f32 v[220:221], v[220:221], s[10:11]
    v_pk_add_f32 v[222:223], v[222:223], s[10:11]
    v_pk_add_f32 v[224:225], v[224:225], s[10:11]
    v_pk_add_f32 v[226:227], v[226:227], s[10:11]
    v_rcp_f32 v212, v212
    v_rcp_f32 v213, v213
    v_rcp_f32 v214, v214
    v_rcp_f32 v215, v215
    v_rcp_f32 v216, v216
    v_rcp_f32 v217, v217
    v_rcp_f32 v218, v218
    v_rcp_f32 v219, v219
    v_rcp_f32 v220, v220
    v_rcp_f32 v221, v221
    v_rcp_f32 v222, v222
    v_rcp_f32 v223, v223
    v_rcp_f32 v224, v224
    v_rcp_f32 v225, v225
    v_rcp_f32 v226, v226
    v_rcp_f32 v227, v227
    s_nop 0
    v_pk_mul_f32 v[164:165], v[164:165], v[212:213]
    v_pk_mul_f32 v[166:167], v[166:167], v[214:215]
    v_pk_mul_f32 v[168:169], v[168:169], v[216:217]
    v_pk_mul_f32 v[170:171], v[170:171], v[218:219]
    v_pk_mul_f32 v[172:173], v[172:173], v[220:221]
    v_pk_mul_f32 v[174:175], v[174:175], v[222:223]
    v_pk_mul_f32 v[176:177], v[176:177], v[224:225]
    v_pk_mul_f32 v[178:179], v[178:179], v[226:227]
    v_cvt_pk_bf16_f32 v60, v164, v165
    v_cvt_pk_bf16_f32 v61, v166, v167
    v_cvt_pk_bf16_f32 v62, v168, v169
    v_cvt_pk_bf16_f32 v63, v170, v171
    v_cvt_pk_bf16_f32 v64, v172, v173
    v_cvt_pk_bf16_f32 v65, v174, v175
    v_cvt_pk_bf16_f32 v66, v176, v177
    v_cvt_pk_bf16_f32 v67, v178, v179
    buffer_store_dwordx4 v[60:63], v2, s[36:39], s6 offen offset:0 sc1
    buffer_store_dwordx4 v[64:67], v2, s[36:39], s6 offen offset:1024 sc1
    v_pk_mul_f32 v[212:213], v[196:197], s[8:9]
    v_pk_mul_f32 v[214:215], v[198:199], s[8:9]
    v_pk_mul_f32 v[216:217], v[200:201], s[8:9]
    v_pk_mul_f32 v[218:219], v[202:203], s[8:9]
    v_exp_f32 v212, v212
    v_exp_f32 v213, v213
    v_exp_f32 v214, v214
    v_exp_f32 v215, v215
    v_exp_f32 v216, v216
    v_exp_f32 v217, v217
    v_exp_f32 v218, v218
    v_exp_f32 v219, v219
    v_pk_mul_f32 v[196:197], v[196:197], v[204:205]
    v_pk_mul_f32 v[198:199], v[198:199], v[206:207]
    v_pk_mul_f32 v[200:201], v[200:201], v[208:209]
    v_pk_mul_f32 v[202:203], v[202:203], v[210:211]
    v_pk_add_f32 v[212:213], v[212:213], s[10:11]
    v_pk_add_f32 v[214:215], v[214:215], s[10:11]
    v_pk_add_f32 v[216:217], v[216:217], s[10:11]
    v_pk_add_f32 v[218:219], v[218:219], s[10:11]
    v_rcp_f32 v212, v212
    v_rcp_f32 v213, v213
    v_rcp_f32 v214, v214
    v_rcp_f32 v215, v215
    v_rcp_f32 v216, v216
    v_rcp_f32 v217, v217
    v_rcp_f32 v218, v218
    v_rcp_f32 v219, v219
    s_nop 0
    v_pk_mul_f32 v[196:197], v[196:197], v[212:213]
    v_pk_mul_f32 v[198:199], v[198:199], v[214:215]
    v_pk_mul_f32 v[200:201], v[200:201], v[216:217]
    v_pk_mul_f32 v[202:203], v[202:203], v[218:219]
    v_cvt_pk_bf16_f32 v68, v196, v197
    v_cvt_pk_bf16_f32 v69, v198, v199
    v_cvt_pk_bf16_f32 v70, v200, v201
    v_cvt_pk_bf16_f32 v71, v202, v203
    buffer_store_dwordx4 v[68:71], v2, s[36:39], s5 offen sc1
    s_lshl_b32 s4, s43, 6
    s_lshl_b32 s5, s42, 2
    s_add_u32 s4, s4, s5
    s_add_u32 s4, s4, 20975616
    v_mov_b32 v212, s83
    v_mov_b32 v213, 0
    s_waitcnt vmcnt(0)
    s_mov_b64 exec, 1
    buffer_store_dword v212, v213, s[36:39], s4 offen sc1
    s_mov_b64 exec, -1
    s_lshl_b32 s66, s12, 7
    s_add_u32 s4, s66, 20975616
    s_setprio 0
    s_cmp_lg_u32 s40, 0
    s_cbranch_scc1 poll6_ok
    v_and_b32 v13, 31, v1
    v_lshlrev_b32 v13, 2, v13
    s_mov_b32 s3, 200000
poll6:
    buffer_load_dword v12, v13, s[36:39], s4 offen sc1
    s_waitcnt vmcnt(0)
    v_cmp_ne_u32 vcc, s83, v12
    s_cbranch_vccz poll6_ok
    s_sleep 4
    s_sub_u32 s3, s3, 1
    s_cmp_lg_u32 s3, 0
    s_cbranch_scc1 poll6
poll6_ok:
    s_waitcnt vmcnt(0)
    s_barrier
    buffer_load_dwordx4 v[128:131], v2, s[36:39], s60 offen offset:0 sc1
    buffer_load_dwordx4 v[132:135], v2, s[36:39], s61 offen offset:0 sc1
    buffer_load_dwordx4 v[136:139], v2, s[36:39], s60 offen offset:1024 sc1
    buffer_load_dwordx4 v[140:143], v2, s[36:39], s61 offen offset:1024 sc1
    buffer_load_dwordx4 v[144:147], v2, s[36:39], s60 offen offset:2048 sc1
    buffer_load_dwordx4 v[148:151], v2, s[36:39], s61 offen offset:2048 sc1
    buffer_load_dwordx4 v[152:155], v2, s[36:39], s60 offen offset:3072 sc1
    buffer_load_dwordx4 v[156:159], v2, s[36:39], s61 offen offset:3072 sc1
    s_add_u32 s60, s60, 4096
    s_add_u32 s61, s61, 4096
    s_sub_u32 s65, s65, 1
    s_cmp_eq_u32 s65, 0
    s_cselect_b32 s6, 28672, 0
    s_sub_u32 s60, s60, s6
    s_sub_u32 s61, s61, s6
    buffer_load_dwordx4 v[160:163], v2, s[36:39], s60 offen offset:0 sc1
    buffer_load_dwordx4 v[164:167], v2, s[36:39], s61 offen offset:0 sc1
    buffer_load_dwordx4 v[168:171], v2, s[36:39], s60 offen offset:1024 sc1
    buffer_load_dwordx4 v[172:175], v2, s[36:39], s61 offen offset:1024 sc1
    buffer_load_dwordx4 v[176:179], v2, s[36:39], s60 offen offset:2048 sc1
    buffer_load_dwordx4 v[180:183], v2, s[36:39], s61 offen offset:2048 sc1
    buffer_load_dwordx4 v[184:187], v2, s[36:39], s60 offen offset:3072 sc1
    buffer_load_dwordx4 v[188:191], v2, s[36:39], s61 offen offset:3072 sc1
    s_add_u32 s60, s60, 4096
    s_add_u32 s61, s61, 4096
    s_sub_u32 s65, s65, 1
    s_cmp_eq_u32 s65, 0
    s_cselect_b32 s6, 28672, 0
    s_sub_u32 s60, s60, s6
    s_sub_u32 s61, s61, s6
    ds_read_b64_tr_b16 v[32:33], v8 offset:0
    ds_read_b64_tr_b16 v[34:35], v8 offset:1024
    ds_read_b64_tr_b16 v[36:37], v8 offset:256
    ds_read_b64_tr_b16 v[38:39], v8 offset:1280
    s_waitcnt vmcnt(14)
    ds_read_b64_tr_b16 v[40:41], v8 offset:2048
    ds_read_b64_tr_b16 v[42:43], v8 offset:3072
    ds_read_b64_tr_b16 v[44:45], v8 offset:2304
    ds_read_b64_tr_b16 v[46:47], v8 offset:3328
    s_waitcnt lgkmcnt(4)
    v_mfma_f32_32x32x16_bf16 v[64:79], v[32:35], v[128:131], 0
    v_mfma_f32_32x32x16_bf16 v[80:95], v[36:39], v[128:131], 0
    v_mfma_f32_32x32x16_bf16 v[96:111], v[32:35], v[132:135], 0
    v_mfma_f32_32x32x16_bf16 v[112:127], v[36:39], v[132:135], 0
    s_add_u32 m0, s56, 0
    s_nop 0
    buffer_load_dwordx4 v4, s[48:51], s53 offen lds
    s_add_u32 m0, s56, 1024
    s_nop 0
    buffer_load_dwordx4 v9, s[48:51], s53 offen lds
    s_add_u32 s53, s53, 16384
    buffer_load_dwordx4 v[128:131], v2, s[36:39], s60 offen offset:0 sc1
    buffer_load_dwordx4 v[132:135], v2, s[36:39], s61 offen offset:0 sc1
    s_waitcnt vmcnt(16)
    ds_read_b64_tr_b16 v[32:33], v8 offset:4096
    ds_read_b64_tr_b16 v[34:35], v8 offset:5120
    ds_read_b64_tr_b16 v[36:37], v8 offset:4352
    ds_read_b64_tr_b16 v[38:39], v8 offset:5376
    s_waitcnt lgkmcnt(4)
    v_mfma_f32_32x32x16_bf16 v[64:79], v[40:43], v[136:139], v[64:79]
    v_mfma_f32_32x32x16_bf16 v[80:95], v[44:47], v[136:139], v[80:95]
    v_mfma_f32_32x32x16_bf16 v[96:111], v[40:43], v[140:143], v[96:111]
    v_mfma_f32_32x32x16_bf16 v[112:127], v[44:47], v[140:143], v[112:127]
    s_add_u32 m0, s56, 2048
    s_nop 0
    buffer_load_dwordx4 v4, s[48:51], s53 offen lds
    s_add_u32 m0, s56, 3072
    s_nop 0
    buffer_load_dwordx4 v9, s[48:51], s53 offen lds
    s_add_u32 s53, s53, 16384
    buffer_load_dwordx4 v[136:139], v2, s[36:39], s60 offen offset:1024 sc1
    buffer_load_dwordx4 v[140:143], v2, s[36:39], s61 offen offset:1024 sc1
    s_waitcnt vmcnt(18)
    ds_read_b64_tr_b16 v[40:41], v8 offset:6144
    ds_read_b64_tr_b16 v[42:43], v8 offset:7168
    ds_read_b64_tr_b16 v[44:45], v8 offset:6400
    ds_read_b64_tr_b16 v[46:47], v8 offset:7424
    s_waitcnt lgkmcnt(4)
    v_mfma_f32_32x32x16_bf16 v[64:79], v[32:35], v[144:147], v[64:79]
    v_mfma_f32_32x32x16_bf16 v[80:95], v[36:39], v[144:147], v[80:95]
    v_mfma_f32_32x32x16_bf16 v[96:111], v[32:35], v[148:151], v[96:111]
    v_mfma_f32_32x32x16_bf16 v[112:127], v[36:39], v[148:151], v[112:127]
    s_add_u32 m0, s56, 4096
    s_nop 0
    buffer_load_dwordx4 v4, s[48:51], s53 offen lds
    s_add_u32 m0, s56, 5120
    s_nop 0
    buffer_load_dwordx4 v9, s[48:51], s53 offen lds
    s_add_u32 s53, s53, 16384
    buffer_load_dwordx4 v[144:147], v2, s[36:39], s60 offen offset:2048 sc1
    buffer_load_dwordx4 v[148:151], v2, s[36:39], s61 offen offset:2048 sc1
    s_waitcnt vmcnt(20)
    ds_read_b64_tr_b16 v[32:33], v8 offset:8192
    ds_read_b64_tr_b16 v[34:35], v8 offset:9216
    ds_read_b64_tr_b16 v[36:37], v8 offset:8448
    ds_read_b64_tr_b16 v[38:39], v8 offset:9472
    s_waitcnt lgkmcnt(4)
    v_mfma_f32_32x32x16_bf16 v[64:79], v[40:43], v[152:155], v[64:79]
    v_mfma_f32_32x32x16_bf16 v[80:95], v[44:47], v[152:155], v[80:95]
    v_mfma_f32_32x32x16_bf16 v[96:111], v[40:43], v[156:159], v[96:111]
    v_mfma_f32_32x32x16_bf16 v[112:127], v[44:47], v[156:159], v[112:127]
    s_add_u32 m0, s56, 6144
    s_nop 0
    buffer_load_dwordx4 v4, s[48:51], s53 offen lds
    s_add_u32 m0, s56, 7168
    s_nop 0
    buffer_load_dwordx4 v9, s[48:51], s53 offen lds
    s_add_u32 s53, s53, 16384
    s_sub_u32 s64, s64, 1
    s_cmp_eq_u32 s64, 0
    s_cselect_b32 s6, 458752, 0
    s_sub_u32 s53, s53, s6
    buffer_load_dwordx4 v[152:155], v2, s[36:39], s60 offen offset:3072 sc1
    buffer_load_dwordx4 v[156:159], v2, s[36:39], s61 offen offset:3072 sc1
    s_add_u32 s60, s60, 4096
    s_add_u32 s61, s61, 4096
    s_sub_u32 s65, s65, 1
    s_cmp_eq_u32 s65, 0
    s_cselect_b32 s6, 28672, 0
    s_sub_u32 s60, s60, s6
    s_sub_u32 s61, s61, s6
    s_waitcnt vmcnt(22)
    ds_read_b64_tr_b16 v[40:41], v8 offset:10240
    ds_read_b64_tr_b16 v[42:43], v8 offset:11264
    ds_read_b64_tr_b16 v[44:45], v8 offset:10496
    ds_read_b64_tr_b16 v[46:47], v8 offset:11520
    s_waitcnt lgkmcnt(4)
    v_mfma_f32_32x32x16_bf16 v[64:79], v[32:35], v[160:163], v[64:79]
    v_mfma_f32_32x32x16_bf16 v[80:95], v[36:39], v[160:163], v[80:95]
    v_mfma_f32_32x32x16_bf16 v[96:111], v[32:35], v[164:167], v[96:111]
    v_mfma_f32_32x32x16_bf16 v[112:127], v[36:39], v[164:167], v[112:127]
    s_add_u32 m0, s56, 8192
    s_nop 0
    buffer_load_dwordx4 v4, s[48:51], s53 offen lds
    s_add_u32 m0, s56, 9216
    s_nop 0
    buffer_load_dwordx4 v9, s[48:51], s53 offen lds
    s_add_u32 s53, s53, 16384
    buffer_load_dwordx4 v[160:163], v2, s[36:39], s60 offen offset:0 sc1
    buffer_load_dwordx4 v[164:167], v2, s[36:39], s61 offen offset:0 sc1
    s_waitcnt vmcnt(24)
    ds_read_b64_tr_b16 v[32:33], v8 offset:12288
    ds_read_b64_tr_b16 v[34:35], v8 offset:13312
    ds_read_b64_tr_b16 v[36:37], v8 offset:12544
    ds_read_b64_tr_b16 v[38:39], v8 offset:13568
    s_waitcnt lgkmcnt(4)
    v_mfma_f32_32x32x16_bf16 v[64:79], v[40:43], v[168:171], v[64:79]
    v_mfma_f32_32x32x16_bf16 v[80:95], v[44:47], v[168:171], v[80:95]
    v_mfma_f32_32x32x16_bf16 v[96:111], v[40:43], v[172:175], v[96:111]
    v_mfma_f32_32x32x16_bf16 v[112:127], v[44:47], v[172:175], v[112:127]
    s_add_u32 m0, s56, 10240
    s_nop 0
    buffer_load_dwordx4 v4, s[48:51], s53 offen lds
    s_add_u32 m0, s56, 11264
    s_nop 0
    buffer_load_dwordx4 v9, s[48:51], s53 offen lds
    s_add_u32 s53, s53, 16384
    buffer_load_dwordx4 v[168:171], v2, s[36:39], s60 offen offset:1024 sc1
    buffer_load_dwordx4 v[172:175], v2, s[36:39], s61 offen offset:1024 sc1
    s_waitcnt vmcnt(26)
    ds_read_b64_tr_b16 v[40:41], v8 offset:14336
    ds_read_b64_tr_b16 v[42:43], v8 offset:15360
    ds_read_b64_tr_b16 v[44:45], v8 offset:14592
    ds_read_b64_tr_b16 v[46:47], v8 offset:15616
    s_waitcnt lgkmcnt(4)
    v_mfma_f32_32x32x16_bf16 v[64:79], v[32:35], v[176:179], v[64:79]
    v_mfma_f32_32x32x16_bf16 v[80:95], v[36:39], v[176:179], v[80:95]
    v_mfma_f32_32x32x16_bf16 v[96:111], v[32:35], v[180:183], v[96:111]
    v_mfma_f32_32x32x16_bf16 v[112:127], v[36:39], v[180:183], v[112:127]
    s_add_u32 m0, s56, 12288
    s_nop 0
    buffer_load_dwordx4 v4, s[48:51], s53 offen lds
    s_add_u32 m0, s56, 13312
    s_nop 0
    buffer_load_dwordx4 v9, s[48:51], s53 offen lds
    s_add_u32 s53, s53, 16384
    buffer_load_dwordx4 v[176:179], v2, s[36:39], s60 offen offset:2048 sc1
    buffer_load_dwordx4 v[180:183], v2, s[36:39], s61 offen offset:2048 sc1
    s_waitcnt vmcnt(26)
    ds_read_b64_tr_b16 v[32:33], v8 offset:0
    ds_read_b64_tr_b16 v[34:35], v8 offset:1024
    ds_read_b64_tr_b16 v[36:37], v8 offset:256
    ds_read_b64_tr_b16 v[38:39], v8 offset:1280
    s_waitcnt lgkmcnt(4)
    v_mfma_f32_32x32x16_bf16 v[64:79], v[40:43], v[184:187], v[64:79]
    v_mfma_f32_32x32x16_bf16 v[80:95], v[44:47], v[184:187], v[80:95]
    v_mfma_f32_32x32x16_bf16 v[96:111], v[40:43], v[188:191], v[96:111]
    v_mfma_f32_32x32x16_bf16 v[112:127], v[44:47], v[188:191], v[112:127]
    s_add_u32 m0, s56, 14336
    s_nop 0
    buffer_load_dwordx4 v4, s[48:51], s53 offen lds
    s_add_u32 m0, s56, 15360
    s_nop 0
    buffer_load_dwordx4 v9, s[48:51], s53 offen lds
    s_add_u32 s53, s53, 16384
    s_sub_u32 s64, s64, 1
    s_cmp_eq_u32 s64, 0
    s_cselect_b32 s6, 458752, 0
    s_sub_u32 s53, s53, s6
    buffer_load_dwordx4 v[184:187], v2, s[36:39], s60 offen offset:3072 sc1
    buffer_load_dwordx4 v[188:191], v2, s[36:39], s61 offen offset:3072 sc1
    s_add_u32 s60, s60, 4096
    s_add_u32 s61, s61, 4096
    s_sub_u32 s65, s65, 1
    s_cmp_eq_u32 s65, 0
    s_cselect_b32 s6, 28672, 0
    s_sub_u32 s60, s60, s6
    s_sub_u32 s61, s61, s6
    s_waitcnt vmcnt(26)
    ds_read_b64_tr_b16 v[40:41], v8 offset:2048
    ds_read_b64_tr_b16 v[42:43], v8 offset:3072
    ds_read_b64_tr_b16 v[44:45], v8 offset:2304
    ds_read_b64_tr_b16 v[46:47], v8 offset:3328
    s_waitcnt lgkmcnt(4)
    v_mfma_f32_32x32x16_bf16 v[64:79], v[32:35], v[128:131], v[64:79]
    v_mfma_f32_32x32x16_bf16 v[80:95], v[36:39], v[128:131], v[80:95]
    v_mfma_f32_32x32x16_bf16 v[96:111], v[32:35], v[132:135], v[96:111]
    v_mfma_f32_32x32x16_bf16 v[112:127], v[36:39], v[132:135], v[112:127]
    s_add_u32 m0, s56, 0
    s_nop 0
    buffer_load_dwordx4 v4, s[48:51], s53 offen lds
    s_add_u32 m0, s56, 1024
    s_nop 0
    buffer_load_dwordx4 v9, s[48:51], s53 offen lds
    s_add_u32 s53, s53, 16384
    buffer_load_dwordx4 v[128:131], v2, s[36:39], s60 offen offset:0 sc1
    buffer_load_dwordx4 v[132:135], v2, s[36:39], s61 offen offset:0 sc1
    s_waitcnt vmcnt(26)
    ds_read_b64_tr_b16 v[32:33], v8 offset:4096
    ds_read_b64_tr_b16 v[34:35], v8 offset:5120
    ds_read_b64_tr_b16 v[36:37], v8 offset:4352
    ds_read_b64_tr_b16 v[38:39], v8 offset:5376
    s_waitcnt lgkmcnt(4)
    v_mfma_f32_32x32x16_bf16 v[64:79], v[40:43], v[136:139], v[64:79]
    v_mfma_f32_32x32x16_bf16 v[80:95], v[44:47], v[136:139], v[80:95]
    v_mfma_f32_32x32x16_bf16 v[96:111], v[40:43], v[140:143], v[96:111]
    v_mfma_f32_32x32x16_bf16 v[112:127], v[44:47], v[140:143], v[112:127]
    s_add_u32 m0, s56, 2048
    s_nop 0
    buffer_load_dwordx4 v4, s[48:51], s53 offen lds
    s_add_u32 m0, s56, 3072
    s_nop 0
    buffer_load_dwordx4 v9, s[48:51], s53 offen lds
    s_add_u32 s53, s53, 16384
    buffer_load_dwordx4 v[136:139], v2, s[36:39], s60 offen offset:1024 sc1
    buffer_load_dwordx4 v[140:143], v2, s[36:39], s61 offen offset:1024 sc1
    s_waitcnt vmcnt(26)
    ds_read_b64_tr_b16 v[40:41], v8 offset:6144
    ds_read_b64_tr_b16 v[42:43], v8 offset:7168
    ds_read_b64_tr_b16 v[44:45], v8 offset:6400
    ds_read_b64_tr_b16 v[46:47], v8 offset:7424
    s_waitcnt lgkmcnt(4)
    v_mfma_f32_32x32x16_bf16 v[64:79], v[32:35], v[144:147], v[64:79]
    v_mfma_f32_32x32x16_bf16 v[80:95], v[36:39], v[144:147], v[80:95]
    v_mfma_f32_32x32x16_bf16 v[96:111], v[32:35], v[148:151], v[96:111]
    v_mfma_f32_32x32x16_bf16 v[112:127], v[36:39], v[148:151], v[112:127]
    s_add_u32 m0, s56, 4096
    s_nop 0
    buffer_load_dwordx4 v4, s[48:51], s53 offen lds
    s_add_u32 m0, s56, 5120
    s_nop 0
    buffer_load_dwordx4 v9, s[48:51], s53 offen lds
    s_add_u32 s53, s53, 16384
    buffer_load_dwordx4 v[144:147], v2, s[36:39], s60 offen offset:2048 sc1
    buffer_load_dwordx4 v[148:151], v2, s[36:39], s61 offen offset:2048 sc1
    s_waitcnt vmcnt(26)
    ds_read_b64_tr_b16 v[32:33], v8 offset:8192
    ds_read_b64_tr_b16 v[34:35], v8 offset:9216
    ds_read_b64_tr_b16 v[36:37], v8 offset:8448
    ds_read_b64_tr_b16 v[38:39], v8 offset:9472
    s_waitcnt lgkmcnt(4)
    v_mfma_f32_32x32x16_bf16 v[64:79], v[40:43], v[152:155], v[64:79]
    v_mfma_f32_32x32x16_bf16 v[80:95], v[44:47], v[152:155], v[80:95]
    v_mfma_f32_32x32x16_bf16 v[96:111], v[40:43], v[156:159], v[96:111]
    v_mfma_f32_32x32x16_bf16 v[112:127], v[44:47], v[156:159], v[112:127]
    s_add_u32 m0, s56, 6144
    s_nop 0
    buffer_load_dwordx4 v4, s[48:51], s53 offen lds
    s_add_u32 m0, s56, 7168
    s_nop 0
    buffer_load_dwordx4 v9, s[48:51], s53 offen lds
    s_add_u32 s53, s53, 16384
    s_sub_u32 s64, s64, 1
    s_cmp_eq_u32 s64, 0
    s_cselect_b32 s6, 458752, 0
    s_sub_u32 s53, s53, s6
    buffer_load_dwordx4 v[152:155], v2, s[36:39], s60 offen offset:3072 sc1
    buffer_load_dwordx4 v[156:159], v2, s[36:39], s61 offen offset:3072 sc1
    s_add_u32 s60, s60, 4096
    s_add_u32 s61, s61, 4096
    s_sub_u32 s65, s65, 1
    s_cmp_eq_u32 s65, 0
    s_cselect_b32 s6, 28672, 0
    s_sub_u32 s60, s60, s6
    s_sub_u32 s61, s61, s6
    s_waitcnt vmcnt(26)
    ds_read_b64_tr_b16 v[40:41], v8 offset:10240
    ds_read_b64_tr_b16 v[42:43], v8 offset:11264
    ds_read_b64_tr_b16 v[44:45], v8 offset:10496
    ds_read_b64_tr_b16 v[46:47], v8 offset:11520
    s_waitcnt lgkmcnt(4)
    v_mfma_f32_32x32x16_bf16 v[64:79], v[32:35], v[160:163], v[64:79]
    v_mfma_f32_32x32x16_bf16 v[80:95], v[36:39], v[160:163], v[80:95]
    v_mfma_f32_32x32x16_bf16 v[96:111], v[32:35], v[164:167], v[96:111]
    v_mfma_f32_32x32x16_bf16 v[112:127], v[36:39], v[164:167], v[112:127]
    s_add_u32 m0, s56, 8192
    s_nop 0
    buffer_load_dwordx4 v4, s[48:51], s53 offen lds
    s_add_u32 m0, s56, 9216
    s_nop 0
    buffer_load_dwordx4 v9, s[48:51], s53 offen lds
    s_add_u32 s53, s53, 16384
    buffer_load_dwordx4 v[160:163], v2, s[36:39], s60 offen offset:0 sc1
    buffer_load_dwordx4 v[164:167], v2, s[36:39], s61 offen offset:0 sc1
    s_waitcnt vmcnt(26)
    ds_read_b64_tr_b16 v[32:33], v8 offset:12288
    ds_read_b64_tr_b16 v[34:35], v8 offset:13312
    ds_read_b64_tr_b16 v[36:37], v8 offset:12544
    ds_read_b64_tr_b16 v[38:39], v8 offset:13568
    s_waitcnt lgkmcnt(4)
    v_mfma_f32_32x32x16_bf16 v[64:79], v[40:43], v[168:171], v[64:79]
    v_mfma_f32_32x32x16_bf16 v[80:95], v[44:47], v[168:171], v[80:95]
    v_mfma_f32_32x32x16_bf16 v[96:111], v[40:43], v[172:175], v[96:111]
    v_mfma_f32_32x32x16_bf16 v[112:127], v[44:47], v[172:175], v[112:127]
    s_add_u32 m0, s56, 10240
    s_nop 0
    buffer_load_dwordx4 v4, s[48:51], s53 offen lds
    s_add_u32 m0, s56, 11264
    s_nop 0
    buffer_load_dwordx4 v9, s[48:51], s53 offen lds
    s_add_u32 s53, s53, 16384
    buffer_load_dwordx4 v[168:171], v2, s[36:39], s60 offen offset:1024 sc1
    buffer_load_dwordx4 v[172:175], v2, s[36:39], s61 offen offset:1024 sc1
    s_waitcnt vmcnt(26)
    ds_read_b64_tr_b16 v[40:41], v8 offset:14336
    ds_read_b64_tr_b16 v[42:43], v8 offset:15360
    ds_read_b64_tr_b16 v[44:45], v8 offset:14592
    ds_read_b64_tr_b16 v[46:47], v8 offset:15616
    s_waitcnt lgkmcnt(4)
    v_mfma_f32_32x32x16_bf16 v[64:79], v[32:35], v[176:179], v[64:79]
    v_mfma_f32_32x32x16_bf16 v[80:95], v[36:39], v[176:179], v[80:95]
    v_mfma_f32_32x32x16_bf16 v[96:111], v[32:35], v[180:183], v[96:111]
    v_mfma_f32_32x32x16_bf16 v[112:127], v[36:39], v[180:183], v[112:127]
    s_add_u32 m0, s56, 12288
    s_nop 0
    buffer_load_dwordx4 v4, s[48:51], s53 offen lds
    s_add_u32 m0, s56, 13312
    s_nop 0
    buffer_load_dwordx4 v9, s[48:51], s53 offen lds
    s_add_u32 s53, s53, 16384
    buffer_load_dwordx4 v[176:179], v2, s[36:39], s60 offen offset:2048 sc1
    buffer_load_dwordx4 v[180:183], v2, s[36:39], s61 offen offset:2048 sc1
    s_waitcnt vmcnt(26)
    ds_read_b64_tr_b16 v[32:33], v8 offset:0
    ds_read_b64_tr_b16 v[34:35], v8 offset:1024
    ds_read_b64_tr_b16 v[36:37], v8 offset:256
    ds_read_b64_tr_b16 v[38:39], v8 offset:1280
    s_waitcnt lgkmcnt(4)
    v_mfma_f32_32x32x16_bf16 v[64:79], v[40:43], v[184:187], v[64:79]
    v_mfma_f32_32x32x16_bf16 v[80:95], v[44:47], v[184:187], v[80:95]
    v_mfma_f32_32x32x16_bf16 v[96:111], v[40:43], v[188:191], v[96:111]
    v_mfma_f32_32x32x16_bf16 v[112:127], v[44:47], v[188:191], v[112:127]
    s_add_u32 m0, s56, 14336
    s_nop 0
    buffer_load_dwordx4 v4, s[48:51], s53 offen lds
    s_add_u32 m0, s56, 15360
    s_nop 0
    buffer_load_dwordx4 v9, s[48:51], s53 offen lds
    s_add_u32 s53, s53, 16384
    s_sub_u32 s64, s64, 1
    s_cmp_eq_u32 s64, 0
    s_cselect_b32 s6, 458752, 0
    s_sub_u32 s53, s53, s6
    buffer_load_dwordx4 v[184:187], v2, s[36:39], s60 offen offset:3072 sc1
    buffer_load_dwordx4 v[188:191], v2, s[36:39], s61 offen offset:3072 sc1
    s_add_u32 s60, s60, 4096
    s_add_u32 s61, s61, 4096
    s_sub_u32 s65, s65, 1
    s_cmp_eq_u32 s65, 0
    s_cselect_b32 s6, 28672, 0
    s_sub_u32 s60, s60, s6
    s_sub_u32 s61, s61, s6
    s_waitcnt vmcnt(26)
    ds_read_b64_tr_b16 v[40:41], v8 offset:2048
    ds_read_b64_tr_b16 v[42:43], v8 offset:3072
    ds_read_b64_tr_b16 v[44:45], v8 offset:2304
    ds_read_b64_tr_b16 v[46:47], v8 offset:3328
    s_waitcnt lgkmcnt(4)
    v_mfma_f32_32x32x16_bf16 v[64:79], v[32:35], v[128:131], v[64:79]
    v_mfma_f32_32x32x16_bf16 v[80:95], v[36:39], v[128:131], v[80:95]
    v_mfma_f32_32x32x16_bf16 v[96:111], v[32:35], v[132:135], v[96:111]
    v_mfma_f32_32x32x16_bf16 v[112:127], v[36:39], v[132:135], v[112:127]
    s_add_u32 m0, s56, 0
    s_nop 0
    buffer_load_dwordx4 v4, s[48:51], s53 offen lds
    s_add_u32 m0, s56, 1024
    s_nop 0
    buffer_load_dwordx4 v9, s[48:51], s53 offen lds
    s_add_u32 s53, s53, 16384
    buffer_load_dwordx4 v[128:131], v2, s[36:39], s60 offen offset:0 sc1
    buffer_load_dwordx4 v[132:135], v2, s[36:39], s61 offen offset:0 sc1
    s_waitcnt vmcnt(26)
    ds_read_b64_tr_b16 v[32:33], v8 offset:4096
    ds_read_b64_tr_b16 v[34:35], v8 offset:5120
    ds_read_b64_tr_b16 v[36:37], v8 offset:4352
    ds_read_b64_tr_b16 v[38:39], v8 offset:5376
    s_waitcnt lgkmcnt(4)
    v_mfma_f32_32x32x16_bf16 v[64:79], v[40:43], v[136:139], v[64:79]
    v_mfma_f32_32x32x16_bf16 v[80:95], v[44:47], v[136:139], v[80:95]
    v_mfma_f32_32x32x16_bf16 v[96:111], v[40:43], v[140:143], v[96:111]
    v_mfma_f32_32x32x16_bf16 v[112:127], v[44:47], v[140:143], v[112:127]
    s_add_u32 m0, s56, 2048
    s_nop 0
    buffer_load_dwordx4 v4, s[48:51], s53 offen lds
    s_add_u32 m0, s56, 3072
    s_nop 0
    buffer_load_dwordx4 v9, s[48:51], s53 offen lds
    s_add_u32 s53, s53, 16384
    buffer_load_dwordx4 v[136:139], v2, s[36:39], s60 offen offset:1024 sc1
    buffer_load_dwordx4 v[140:143], v2, s[36:39], s61 offen offset:1024 sc1
    s_waitcnt vmcnt(26)
    ds_read_b64_tr_b16 v[40:41], v8 offset:6144
    ds_read_b64_tr_b16 v[42:43], v8 offset:7168
    ds_read_b64_tr_b16 v[44:45], v8 offset:6400
    ds_read_b64_tr_b16 v[46:47], v8 offset:7424
    s_waitcnt lgkmcnt(4)
    v_mfma_f32_32x32x16_bf16 v[64:79], v[32:35], v[144:147], v[64:79]
    v_mfma_f32_32x32x16_bf16 v[80:95], v[36:39], v[144:147], v[80:95]
    v_mfma_f32_32x32x16_bf16 v[96:111], v[32:35], v[148:151], v[96:111]
    v_mfma_f32_32x32x16_bf16 v[112:127], v[36:39], v[148:151], v[112:127]
    s_add_u32 m0, s56, 4096
    s_nop 0
    buffer_load_dwordx4 v4, s[48:51], s53 offen lds
    s_add_u32 m0, s56, 5120
    s_nop 0
    buffer_load_dwordx4 v9, s[48:51], s53 offen lds
    s_add_u32 s53, s53, 16384
    buffer_load_dwordx4 v[144:147], v2, s[36:39], s60 offen offset:2048 sc1
    buffer_load_dwordx4 v[148:151], v2, s[36:39], s61 offen offset:2048 sc1
    s_waitcnt vmcnt(26)
    ds_read_b64_tr_b16 v[32:33], v8 offset:8192
    ds_read_b64_tr_b16 v[34:35], v8 offset:9216
    ds_read_b64_tr_b16 v[36:37], v8 offset:8448
    ds_read_b64_tr_b16 v[38:39], v8 offset:9472
    s_waitcnt lgkmcnt(4)
    v_mfma_f32_32x32x16_bf16 v[64:79], v[40:43], v[152:155], v[64:79]
    v_mfma_f32_32x32x16_bf16 v[80:95], v[44:47], v[152:155], v[80:95]
    v_mfma_f32_32x32x16_bf16 v[96:111], v[40:43], v[156:159], v[96:111]
    v_mfma_f32_32x32x16_bf16 v[112:127], v[44:47], v[156:159], v[112:127]
    s_add_u32 m0, s56, 6144
    s_nop 0
    buffer_load_dwordx4 v4, s[48:51], s53 offen lds
    s_add_u32 m0, s56, 7168
    s_nop 0
    buffer_load_dwordx4 v9, s[48:51], s53 offen lds
    s_add_u32 s53, s53, 16384
    s_sub_u32 s64, s64, 1
    s_cmp_eq_u32 s64, 0
    s_cselect_b32 s6, 458752, 0
    s_sub_u32 s53, s53, s6
    buffer_load_dwordx4 v[152:155], v2, s[36:39], s60 offen offset:3072 sc1
    buffer_load_dwordx4 v[156:159], v2, s[36:39], s61 offen offset:3072 sc1
    s_add_u32 s60, s60, 4096
    s_add_u32 s61, s61, 4096
    s_sub_u32 s65, s65, 1
    s_cmp_eq_u32 s65, 0
    s_cselect_b32 s6, 28672, 0
    s_sub_u32 s60, s60, s6
    s_sub_u32 s61, s61, s6
    s_waitcnt vmcnt(26)
    ds_read_b64_tr_b16 v[40:41], v8 offset:10240
    ds_read_b64_tr_b16 v[42:43], v8 offset:11264
    ds_read_b64_tr_b16 v[44:45], v8 offset:10496
    ds_read_b64_tr_b16 v[46:47], v8 offset:11520
    s_waitcnt lgkmcnt(4)
    v_mfma_f32_32x32x16_bf16 v[64:79], v[32:35], v[160:163], v[64:79]
    v_mfma_f32_32x32x16_bf16 v[80:95], v[36:39], v[160:163], v[80:95]
    v_mfma_f32_32x32x16_bf16 v[96:111], v[32:35], v[164:167], v[96:111]
    v_mfma_f32_32x32x16_bf16 v[112:127], v[36:39], v[164:167], v[112:127]
    s_add_u32 m0, s56, 8192
    s_nop 0
    buffer_load_dwordx4 v4, s[44:47], s52 offen lds
    s_add_u32 m0, s56, 9216
    s_nop 0
    buffer_load_dwordx4 v9, s[44:47], s52 offen lds
    s_add_u32 s52, s52, 16384
    s_waitcnt vmcnt(24)
    ds_read_b64_tr_b16 v[32:33], v8 offset:12288
    ds_read_b64_tr_b16 v[34:35], v8 offset:13312
    ds_read_b64_tr_b16 v[36:37], v8 offset:12544
    ds_read_b64_tr_b16 v[38:39], v8 offset:13568
    s_waitcnt lgkmcnt(4)
    v_mfma_f32_32x32x16_bf16 v[64:79], v[40:43], v[168:171], v[64:79]
    v_mfma_f32_32x32x16_bf16 v[80:95], v[44:47], v[168:171], v[80:95]
    v_mfma_f32_32x32x16_bf16 v[96:111], v[40:43], v[172:175], v[96:111]
    v_mfma_f32_32x32x16_bf16 v[112:127], v[44:47], v[172:175], v[112:127]
    s_add_u32 m0, s56, 10240
    s_nop 0
    buffer_load_dwordx4 v4, s[44:47], s52 offen lds
    s_add_u32 m0, s56, 11264
    s_nop 0
    buffer_load_dwordx4 v9, s[44:47], s52 offen lds
    s_add_u32 s52, s52, 16384
    s_waitcnt vmcnt(22)
    ds_read_b64_tr_b16 v[40:41], v8 offset:14336
    ds_read_b64_tr_b16 v[42:43], v8 offset:15360
    ds_read_b64_tr_b16 v[44:45], v8 offset:14592
    ds_read_b64_tr_b16 v[46:47], v8 offset:15616
    s_waitcnt lgkmcnt(4)
    v_mfma_f32_32x32x16_bf16 v[64:79], v[32:35], v[176:179], v[64:79]
    v_mfma_f32_32x32x16_bf16 v[80:95], v[36:39], v[176:179], v[80:95]
    v_mfma_f32_32x32x16_bf16 v[96:111], v[32:35], v[180:183], v[96:111]
    v_mfma_f32_32x32x16_bf16 v[112:127], v[36:39], v[180:183], v[112:127]
    s_add_u32 m0, s56, 12288
    s_nop 0
    buffer_load_dwordx4 v4, s[44:47], s52 offen lds
    s_add_u32 m0, s56, 13312
    s_nop 0
    buffer_load_dwordx4 v9, s[44:47], s52 offen lds
    s_add_u32 s52, s52, 16384
    s_waitcnt vmcnt(20)
    ds_read_b64_tr_b16 v[32:33], v8 offset:0
    ds_read_b64_tr_b16 v[34:35], v8 offset:1024
    ds_read_b64_tr_b16 v[36:37], v8 offset:256
    ds_read_b64_tr_b16 v[38:39], v8 offset:1280
    s_waitcnt lgkmcnt(4)
    v_mfma_f32_32x32x16_bf16 v[64:79], v[40:43], v[184:187], v[64:79]
    v_mfma_f32_32x32x16_bf16 v[80:95], v[44:47], v[184:187], v[80:95]
    v_mfma_f32_32x32x16_bf16 v[96:111], v[40:43], v[188:191], v[96:111]
    v_mfma_f32_32x32x16_bf16 v[112:127], v[44:47], v[188:191], v[112:127]
    s_add_u32 m0, s56, 14336
    s_nop 0
    buffer_load_dwordx4 v4, s[44:47], s52 offen lds
    s_add_u32 m0, s56, 15360
    s_nop 0
    buffer_load_dwordx4 v9, s[44:47], s52 offen lds
    s_add_u32 s52, s52, 16384
    s_waitcnt vmcnt(18)
    ds_read_b64_tr_b16 v[40:41], v8 offset:2048
    ds_read_b64_tr_b16 v[42:43], v8 offset:3072
    ds_read_b64_tr_b16 v[44:45], v8 offset:2304
    ds_read_b64_tr_b16 v[46:47], v8 offset:3328
    s_waitcnt lgkmcnt(4)
    v_mfma_f32_32x32x16_bf16 v[64:79], v[32:35], v[128:131], v[64:79]
    v_mfma_f32_32x32x16_bf16 v[80:95], v[36:39], v[128:131], v[80:95]
    v_mfma_f32_32x32x16_bf16 v[96:111], v[32:35], v[132:135], v[96:111]
    v_mfma_f32_32x32x16_bf16 v[112:127], v[36:39], v[132:135], v[112:127]
    s_add_u32 m0, s56, 0
    s_nop 0
    buffer_load_dwordx4 v4, s[44:47], s52 offen lds
    s_add_u32 m0, s56, 1024
    s_nop 0
    buffer_load_dwordx4 v9, s[44:47], s52 offen lds
    s_add_u32 s52, s52, 16384
    s_waitcnt vmcnt(16)
    ds_read_b64_tr_b16 v[32:33], v8 offset:4096
    ds_read_b64_tr_b16 v[34:35], v8 offset:5120
    ds_read_b64_tr_b16 v[36:37], v8 offset:4352
    ds_read_b64_tr_b16 v[38:39], v8 offset:5376
    s_waitcnt lgkmcnt(4)
    v_mfma_f32_32x32x16_bf16 v[64:79], v[40:43], v[136:139], v[64:79]
    v_mfma_f32_32x32x16_bf16 v[80:95], v[44:47], v[136:139], v[80:95]
    v_mfma_f32_32x32x16_bf16 v[96:111], v[40:43], v[140:143], v[96:111]
    v_mfma_f32_32x32x16_bf16 v[112:127], v[44:47], v[140:143], v[112:127]
    s_add_u32 m0, s56, 2048
    s_nop 0
    buffer_load_dwordx4 v4, s[44:47], s52 offen lds
    s_add_u32 m0, s56, 3072
    s_nop 0
    buffer_load_dwordx4 v9, s[44:47], s52 offen lds
    s_add_u32 s52, s52, 16384
    s_waitcnt vmcnt(14)
    ds_read_b64_tr_b16 v[40:41], v8 offset:6144
    ds_read_b64_tr_b16 v[42:43], v8 offset:7168
    ds_read_b64_tr_b16 v[44:45], v8 offset:6400
    ds_read_b64_tr_b16 v[46:47], v8 offset:7424
    s_waitcnt lgkmcnt(4)
    v_mfma_f32_32x32x16_bf16 v[64:79], v[32:35], v[144:147], v[64:79]
    v_mfma_f32_32x32x16_bf16 v[80:95], v[36:39], v[144:147], v[80:95]
    v_mfma_f32_32x32x16_bf16 v[96:111], v[32:35], v[148:151], v[96:111]
    v_mfma_f32_32x32x16_bf16 v[112:127], v[36:39], v[148:151], v[112:127]
    s_add_u32 m0, s56, 4096
    s_nop 0
    buffer_load_dwordx4 v4, s[44:47], s52 offen lds
    s_add_u32 m0, s56, 5120
    s_nop 0
    buffer_load_dwordx4 v9, s[44:47], s52 offen lds
    s_add_u32 s52, s52, 16384
    s_waitcnt vmcnt(12)
    ds_read_b64_tr_b16 v[32:33], v8 offset:8192
    ds_read_b64_tr_b16 v[34:35], v8 offset:9216
    ds_read_b64_tr_b16 v[36:37], v8 offset:8448
    ds_read_b64_tr_b16 v[38:39], v8 offset:9472
    s_waitcnt lgkmcnt(4)
    v_mfma_f32_32x32x16_bf16 v[64:79], v[40:43], v[152:155], v[64:79]
    v_mfma_f32_32x32x16_bf16 v[80:95], v[44:47], v[152:155], v[80:95]
    v_mfma_f32_32x32x16_bf16 v[96:111], v[40:43], v[156:159], v[96:111]
    v_mfma_f32_32x32x16_bf16 v[112:127], v[44:47], v[156:159], v[112:127]
    s_add_u32 m0, s56, 6144
    s_nop 0
    buffer_load_dwordx4 v4, s[44:47], s52 offen lds
    s_add_u32 m0, s56, 7168
    s_nop 0
    buffer_load_dwordx4 v9, s[44:47], s52 offen lds
    s_add_u32 s52, s52, 16384
    s_add_u32 s4, s66, 20979712
    s_cmp_lg_u32 s40, 0
    s_cbranch_scc1 poll7_ok
    v_and_b32 v13, 31, v1
    v_lshlrev_b32 v13, 2, v13
    s_mov_b32 s3, 200000
poll7:
    buffer_load_dword v12, v13, s[36:39], s4 offen sc1
    s_waitcnt vmcnt(0)
    v_cmp_ne_u32 vcc, s83, v12
    s_cbranch_vccz poll7_ok
    s_sleep 4
    s_sub_u32 s3, s3, 1
    s_cmp_lg_u32 s3, 0
    s_cbranch_scc1 poll7
poll7_ok:
    s_waitcnt vmcnt(0)
    s_barrier
    buffer_load_dwordx4 v[160:163], v2, s[36:39], s62 offen offset:0 sc1
    buffer_load_dwordx4 v[164:167], v2, s[36:39], s63 offen offset:0 sc1
    buffer_load_dwordx4 v[168:171], v2, s[36:39], s62 offen offset:1024 sc1
    buffer_load_dwordx4 v[172:175], v2, s[36:39], s63 offen offset:1024 sc1
    buffer_load_dwordx4 v[176:179], v2, s[36:39], s62 offen offset:2048 sc1
    buffer_load_dwordx4 v[180:183], v2, s[36:39], s63 offen offset:2048 sc1
    buffer_load_dwordx4 v[184:187], v2, s[36:39], s62 offen offset:3072 sc1
    buffer_load_dwordx4 v[188:191], v2, s[36:39], s63 offen offset:3072 sc1
    s_add_u32 s62, s62, 4096
    s_add_u32 s63, s63, 4096
    buffer_load_dwordx4 v[128:131], v2, s[36:39], s62 offen offset:0 sc1
    buffer_load_dwordx4 v[132:135], v2, s[36:39], s63 offen offset:0 sc1
    buffer_load_dwordx4 v[136:139], v2, s[36:39], s62 offen offset:1024 sc1
    buffer_load_dwordx4 v[140:143], v2, s[36:39], s63 offen offset:1024 sc1
    buffer_load_dwordx4 v[144:147], v2, s[36:39], s62 offen offset:2048 sc1
    buffer_load_dwordx4 v[148:151], v2, s[36:39], s63 offen offset:2048 sc1
    buffer_load_dwordx4 v[152:155], v2, s[36:39], s62 offen offset:3072 sc1
    buffer_load_dwordx4 v[156:159], v2, s[36:39], s63 offen offset:3072 sc1
    s_add_u32 s62, s62, 4096
    s_add_u32 s63, s63, 4096
    s_waitcnt vmcnt(14)
    ds_read_b64_tr_b16 v[40:41], v8 offset:10240
    ds_read_b64_tr_b16 v[42:43], v8 offset:11264
    ds_read_b64_tr_b16 v[44:45], v8 offset:10496
    ds_read_b64_tr_b16 v[46:47], v8 offset:11520
    s_waitcnt lgkmcnt(4)
    v_mfma_f32_32x32x16_bf16 v[64:79], v[32:35], v[160:163], v[64:79]
    v_mfma_f32_32x32x16_bf16 v[80:95], v[36:39], v[160:163], v[80:95]
    v_mfma_f32_32x32x16_bf16 v[96:111], v[32:35], v[164:167], v[96:111]
    v_mfma_f32_32x32x16_bf16 v[112:127], v[36:39], v[164:167], v[112:127]
    s_waitcnt vmcnt(12)
    ds_read_b64_tr_b16 v[32:33], v8 offset:12288
    ds_read_b64_tr_b16 v[34:35], v8 offset:13312
    ds_read_b64_tr_b16 v[36:37], v8 offset:12544
    ds_read_b64_tr_b16 v[38:39], v8 offset:13568
    s_waitcnt lgkmcnt(4)
    v_mfma_f32_32x32x16_bf16 v[64:79], v[40:43], v[168:171], v[64:79]
    v_mfma_f32_32x32x16_bf16 v[80:95], v[44:47], v[168:171], v[80:95]
    v_mfma_f32_32x32x16_bf16 v[96:111], v[40:43], v[172:175], v[96:111]
    v_mfma_f32_32x32x16_bf16 v[112:127], v[44:47], v[172:175], v[112:127]
    s_waitcnt vmcnt(10)
    ds_read_b64_tr_b16 v[40:41], v8 offset:14336
    ds_read_b64_tr_b16 v[42:43], v8 offset:15360
    ds_read_b64_tr_b16 v[44:45], v8 offset:14592
    ds_read_b64_tr_b16 v[46:47], v8 offset:15616
    s_waitcnt lgkmcnt(4)
    v_mfma_f32_32x32x16_bf16 v[64:79], v[32:35], v[176:179], v[64:79]
    v_mfma_f32_32x32x16_bf16 v[80:95], v[36:39], v[176:179], v[80:95]
    v_mfma_f32_32x32x16_bf16 v[96:111], v[32:35], v[180:183], v[96:111]
    v_mfma_f32_32x32x16_bf16 v[112:127], v[36:39], v[180:183], v[112:127]
    s_waitcnt vmcnt(8)
    ds_read_b64_tr_b16 v[32:33], v8 offset:0
    ds_read_b64_tr_b16 v[34:35], v8 offset:1024
    ds_read_b64_tr_b16 v[36:37], v8 offset:256
    ds_read_b64_tr_b16 v[38:39], v8 offset:1280
    s_waitcnt lgkmcnt(4)
    v_mfma_f32_32x32x16_bf16 v[64:79], v[40:43], v[184:187], v[64:79]
    v_mfma_f32_32x32x16_bf16 v[80:95], v[44:47], v[184:187], v[80:95]
    v_mfma_f32_32x32x16_bf16 v[96:111], v[40:43], v[188:191], v[96:111]
    v_mfma_f32_32x32x16_bf16 v[112:127], v[44:47], v[188:191], v[112:127]
    s_waitcnt vmcnt(6)
    ds_read_b64_tr_b16 v[40:41], v8 offset:2048
    ds_read_b64_tr_b16 v[42:43], v8 offset:3072
    ds_read_b64_tr_b16 v[44:45], v8 offset:2304
    ds_read_b64_tr_b16 v[46:47], v8 offset:3328
    s_waitcnt lgkmcnt(4)
    v_mfma_f32_32x32x16_bf16 v[64:79], v[32:35], v[128:131], v[64:79]
    v_mfma_f32_32x32x16_bf16 v[80:95], v[36:39], v[128:131], v[80:95]
    v_mfma_f32_32x32x16_bf16 v[96:111], v[32:35], v[132:135], v[96:111]
    v_mfma_f32_32x32x16_bf16 v[112:127], v[36:39], v[132:135], v[112:127]
    s_waitcnt vmcnt(4)
    ds_read_b64_tr_b16 v[32:33], v8 offset:4096
    ds_read_b64_tr_b16 v[34:35], v8 offset:5120
    ds_read_b64_tr_b16 v[36:37], v8 offset:4352
    ds_read_b64_tr_b16 v[38:39], v8 offset:5376
    s_waitcnt lgkmcnt(4)
    v_mfma_f32_32x32x16_bf16 v[64:79], v[40:43], v[136:139], v[64:79]
    v_mfma_f32_32x32x16_bf16 v[80:95], v[44:47], v[136:139], v[80:95]
    v_mfma_f32_32x32x16_bf16 v[96:111], v[40:43], v[140:143], v[96:111]
    v_mfma_f32_32x32x16_bf16 v[112:127], v[44:47], v[140:143], v[112:127]
    s_waitcnt vmcnt(2)
    ds_read_b64_tr_b16 v[40:41], v8 offset:6144
    ds_read_b64_tr_b16 v[42:43], v8 offset:7168
    ds_read_b64_tr_b16 v[44:45], v8 offset:6400
    ds_read_b64_tr_b16 v[46:47], v8 offset:7424
    s_waitcnt lgkmcnt(4)
    v_mfma_f32_32x32x16_bf16 v[64:79], v[32:35], v[144:147], v[64:79]
    v_mfma_f32_32x32x16_bf16 v[80:95], v[36:39], v[144:147], v[80:95]
    v_mfma_f32_32x32x16_bf16 v[96:111], v[32:35], v[148:151], v[96:111]
    v_mfma_f32_32x32x16_bf16 v[112:127], v[36:39], v[148:151], v[112:127]
    s_waitcnt vmcnt(0)
    s_waitcnt lgkmcnt(0)
    v_mfma_f32_32x32x16_bf16 v[64:79], v[40:43], v[152:155], v[64:79]
    v_mfma_f32_32x32x16_bf16 v[80:95], v[44:47], v[152:155], v[80:95]
    v_mfma_f32_32x32x16_bf16 v[96:111], v[40:43], v[156:159], v[96:111]
    v_mfma_f32_32x32x16_bf16 v[112:127], v[44:47], v[156:159], v[112:127]
    s_setprio 3
    s_barrier
    v_and_b32 v9, 31, v1
    v_mul_u32_u24 v9, 272, v9
    v_lshl_add_u32 v9, v3, 4, v9
    s_mul_i32 s56, s40, 17408
    v_add_u32 v9, s56, v9
    v_lshrrev_b32 v10, 3, v0
    v_and_b32 v11, 7, v0
    s_lshl_b32 s57, s12, 6
    v_add_u32 v12, s57, v10
    v_lshlrev_b32 v12, 10, v12
    v_lshl_add_u32 v12, v11, 4, v12
    s_lshl_b32 s57, s13, 7
    v_add_u32 v12, s57, v12
    s_mov_b32 s44, s16
    s_mov_b32 s45, s17
    s_mov_b32 s46, 2097152
    s_mov_b32 s47, 0x00020000
    s_mov_b32 s48, s30
    s_mov_b32 s49, s31
    s_mov_b32 s50, 2097152
    s_mov_b32 s51, 0x00020000
    s_mov_b32 s58, 32768
    buffer_load_dwordx4 v[16:19], v12, s[44:47], 0 offen
    buffer_load_dwordx4 v[20:23], v12, s[44:47], s58 offen
    ds_write_b128 v9, v[64:67] offset:0
    ds_write_b128 v9, v[68:71] offset:32
    ds_write_b128 v9, v[72:75] offset:64
    ds_write_b128 v9, v[76:79] offset:96
    ds_write_b128 v9, v[80:83] offset:128
    ds_write_b128 v9, v[84:87] offset:160
    ds_write_b128 v9, v[88:91] offset:192
    ds_write_b128 v9, v[92:95] offset:224
    ds_write_b128 v9, v[96:99] offset:8704
    ds_write_b128 v9, v[100:103] offset:8736
    ds_write_b128 v9, v[104:107] offset:8768
    ds_write_b128 v9, v[108:111] offset:8800
    ds_write_b128 v9, v[112:115] offset:8832
    ds_write_b128 v9, v[116:119] offset:8864
    ds_write_b128 v9, v[120:123] offset:8896
    ds_write_b128 v9, v[124:127] offset:8928
    v_mul_u32_u24 v13, 272, v10
    v_lshl_add_u32 v13, v11, 5, v13
    s_waitcnt lgkmcnt(0)
    s_barrier
    ds_read_b128 v[128:131], v13 offset:0
    ds_read_b128 v[132:135], v13 offset:16
    ds_read_b128 v[136:139], v13 offset:17408
    ds_read_b128 v[140:143], v13 offset:17424
    ds_read_b128 v[144:147], v13 offset:34816
    ds_read_b128 v[148:151], v13 offset:34832
    ds_read_b128 v[152:155], v13 offset:52224
    ds_read_b128 v[156:159], v13 offset:52240
    ds_read_b128 v[160:163], v13 offset:8704
    ds_read_b128 v[164:167], v13 offset:8720
    ds_read_b128 v[168:171], v13 offset:26112
    ds_read_b128 v[172:175], v13 offset:26128
    ds_read_b128 v[176:179], v13 offset:43520
    ds_read_b128 v[180:183], v13 offset:43536
    ds_read_b128 v[184:187], v13 offset:60928
    ds_read_b128 v[188:191], v13 offset:60944
    s_waitcnt vmcnt(0)
    v_lshlrev_b32 v24, 16, v16
    v_and_b32 v25, 0xffff0000, v16
    v_lshlrev_b32 v26, 16, v17
    v_and_b32 v27, 0xffff0000, v17
    v_lshlrev_b32 v28, 16, v18
    v_and_b32 v29, 0xffff0000, v18
    v_lshlrev_b32 v30, 16, v19
    v_and_b32 v31, 0xffff0000, v19
    v_lshlrev_b32 v32, 16, v20
    v_and_b32 v33, 0xffff0000, v20
    v_lshlrev_b32 v34, 16, v21
    v_and_b32 v35, 0xffff0000, v21
    v_lshlrev_b32 v36, 16, v22
    v_and_b32 v37, 0xffff0000, v22
    v_lshlrev_b32 v38, 16, v23
    v_and_b32 v39, 0xffff0000, v23
    s_waitcnt lgkmcnt(8)
    v_add_f32 v24, v24, v128
    v_add_f32 v25, v25, v129
    v_add_f32 v26, v26, v130
    v_add_f32 v27, v27, v131
    v_add_f32 v28, v28, v132
    v_add_f32 v29, v29, v133
    v_add_f32 v30, v30, v134
    v_add_f32 v31, v31, v135
    v_add_f32 v24, v24, v136
    v_add_f32 v25, v25, v137
    v_add_f32 v26, v26, v138
    v_add_f32 v27, v27, v139
    v_add_f32 v28, v28, v140
    v_add_f32 v29, v29, v141
    v_add_f32 v30, v30, v142
    v_add_f32 v31, v31, v143
    v_add_f32 v24, v24, v144
    v_add_f32 v25, v25, v145
    v_add_f32 v26, v26, v146
    v_add_f32 v27, v27, v147
    v_add_f32 v28, v28, v148
    v_add_f32 v29, v29, v149
    v_add_f32 v30, v30, v150
    v_add_f32 v31, v31, v151
    v_add_f32 v24, v24, v152
    v_add_f32 v25, v25, v153
    v_add_f32 v26, v26, v154
    v_add_f32 v27, v27, v155
    v_add_f32 v28, v28, v156
    v_add_f32 v29, v29, v157
    v_add_f32 v30, v30, v158
    v_add_f32 v31, v31, v159
    v_cvt_pk_bf16_f32 v40, v24, v25
    v_cvt_pk_bf16_f32 v41, v26, v27
    v_cvt_pk_bf16_f32 v42, v28, v29
    v_cvt_pk_bf16_f32 v43, v30, v31
    buffer_store_dwordx4 v[40:43], v12, s[48:51], 0 offen
    s_waitcnt lgkmcnt(0)
    v_add_f32 v32, v32, v160
    v_add_f32 v33, v33, v161
    v_add_f32 v34, v34, v162
    v_add_f32 v35, v35, v163
    v_add_f32 v36, v36, v164
    v_add_f32 v37, v37, v165
    v_add_f32 v38, v38, v166
    v_add_f32 v39, v39, v167
    v_add_f32 v32, v32, v168
    v_add_f32 v33, v33, v169
    v_add_f32 v34, v34, v170
    v_add_f32 v35, v35, v171
    v_add_f32 v36, v36, v172
    v_add_f32 v37, v37, v173
    v_add_f32 v38, v38, v174
    v_add_f32 v39, v39, v175
    v_add_f32 v32, v32, v176
    v_add_f32 v33, v33, v177
    v_add_f32 v34, v34, v178
    v_add_f32 v35, v35, v179
    v_add_f32 v36, v36, v180
    v_add_f32 v37, v37, v181
    v_add_f32 v38, v38, v182
    v_add_f32 v39, v39, v183
    v_add_f32 v32, v32, v184
    v_add_f32 v33, v33, v185
    v_add_f32 v34, v34, v186
    v_add_f32 v35, v35, v187
    v_add_f32 v36, v36, v188
    v_add_f32 v37, v37, v189
    v_add_f32 v38, v38, v190
    v_add_f32 v39, v39, v191
    v_cvt_pk_bf16_f32 v44, v32, v33
    v_cvt_pk_bf16_f32 v45, v34, v35
    v_cvt_pk_bf16_f32 v46, v36, v37
    v_cvt_pk_bf16_f32 v47, v38, v39
    buffer_store_dwordx4 v[44:47], v12, s[48:51], s58 offen
    s_endpgm
parallel_sum__mha_block__swiglu_ffn__prompt_kernel_done:
    s_endpgm
.section .rodata,"a"
.p2align 6
.amdhsa_kernel parallel_sum__mha_block__swiglu_ffn__prompt_kernel
  .amdhsa_next_free_vgpr 256
  .amdhsa_next_free_sgpr 102
  .amdhsa_accum_offset 256
  .amdhsa_group_segment_fixed_size 0
  .amdhsa_kernarg_size 80
  .amdhsa_user_sgpr_count 2
  .amdhsa_user_sgpr_kernarg_segment_ptr 1
  .amdhsa_system_sgpr_workgroup_id_x 1
.end_amdhsa_kernel
```
